```python
import torch

def _softmax(x, axis=-1):
    return torch.softmax(x, dim=axis)
def _gelu(x):
    return torch.nn.functional.gelu(x, approximate="tanh")
def _silu(x):
    return torch.nn.functional.silu(x)
def _sigmoid(x):
    return torch.sigmoid(x)
def _layernorm(x, axis=-1, eps=1e-5):
    m = x.mean(dim=axis, keepdim=True)
    v = x.var(dim=axis, keepdim=True, unbiased=False)
    return (x - m) / torch.sqrt(v + eps)
def _scatter_add(tgt, idx, src, axis=0):
    return tgt.clone().index_add_(axis, idx, src)
def _segment_sum(src, seg, n):
    out = torch.zeros((n,) + src.shape[1:], dtype=src.dtype)
    return out.index_add_(0, seg, src)
def _pad(x, pw):
    flat = tuple(v for pair in reversed(pw) for v in pair)
    return torch.nn.functional.pad(x, flat)

kernel_name = 'concat_heads__ssm_conv_s4d__softmax_full_mha__prompt'

def setup_inputs():

    _w = (lambda a: (lambda t: t.to(torch.bfloat16) if t.is_floating_point() else t)(torch.as_tensor(a)))
    def _A_setup():
        Bsz, L, D, N = 1, 2048, 448, 256
        return {
            "u": _w((lambda *s: torch.randn(*s, dtype=torch.bfloat16) * 0.05)(Bsz, L, D)),
            "log_A_real": _w((lambda *s: torch.randn(*s, dtype=torch.bfloat16) * 6.4)(D, N) * 0.5),
            "A_imag": _w((lambda *s: torch.randn(*s, dtype=torch.bfloat16) * 0.1)(D, N) * 3.14),
            "C_real": _w((lambda *s: torch.randn(*s, dtype=torch.bfloat16) * 0.4)(D, N) / N ** 0.5),
            "C_imag": _w((lambda *s: torch.randn(*s, dtype=torch.bfloat16) * 0.4)(D, N) / N ** 0.5),
            "log_dt": _w((lambda *s: torch.randn(*s, dtype=torch.bfloat16) * 0.1)(D) * 0.5 - 4.0),
            "D_skip": _w((lambda *s: torch.randn(*s, dtype=torch.bfloat16) * 0.1)(D)),
        }
    _A_in = _A_setup()

    def _B_setup():
        B, S, D = 1, 2048, 448
        return {
            "x": _w((lambda *s: torch.randn(*s, dtype=torch.bfloat16) * 0.2)(B, S, D)),
            "wqkv": _w((lambda *s: torch.randn(*s, dtype=torch.bfloat16) * 0.2)(D, 3 * D)),
            "wo": _w((lambda *s: torch.randn(*s, dtype=torch.bfloat16) * 0.05)(D, D)),
        }
    _B_in = _B_setup()

    return {
        "A_u": _A_in["u"],
        "A_log_A_real": _A_in["log_A_real"],
        "A_A_imag": _A_in["A_imag"],
        "A_C_real": _A_in["C_real"],
        "A_C_imag": _A_in["C_imag"],
        "A_log_dt": _A_in["log_dt"],
        "A_D_skip": _A_in["D_skip"],
        "B_x": _B_in["x"],
        "B_wqkv": _B_in["wqkv"],
        "B_wo": _B_in["wo"],
    }

def reference(A_u, A_log_A_real, A_A_imag, A_C_real, A_C_imag, A_log_dt, A_D_skip, B_x, B_wqkv, B_wo):
    def _A_ref(u, log_A_real, A_imag, C_real, C_imag, log_dt, D_skip):
        L = u.shape[1]
        dt = torch.exp(log_dt)
        A = -torch.exp(log_A_real) + 1j * A_imag
        C = (C_real + 1j * C_imag) * dt[:, None]
        pos = (lambda x, dt: x.to(dt))(torch.arange(L), log_dt.dtype)
        P = torch.exp((A * dt[:, None])[:, :, None] * pos[None, None, :])
        K = 2.0 * torch.einsum("dn,dnl->dl", C, P).real
        L2 = 2 * L
        u_t = (lambda x, *d: x.permute(*d))(u, 0, 2, 1)
        Kf = (lambda x, *a, **k: torch.fft.rfft(x.float(), *a, **k))(K, L2)
        Uf = (lambda x, *a, **k: torch.fft.rfft(x.float(), *a, **k))(u_t, L2)
        y = (lambda x, *a, **k: torch.fft.irfft(x, *a, **k).to(torch.bfloat16))(Uf * Kf[None, :, :], L2)[:, :, :L]
        y = (lambda x, *d: x.permute(*d))(y, 0, 2, 1)
        return y + u * D_skip[None, None, :]

    def _B_ref(x, wqkv, wo):
        B, S, D = x.shape
        H = 16; Dh = D // H
        qkv = (lambda x, *d: x.permute(*d))((x @ wqkv).reshape(B, S, 3, H, Dh), 2, 0, 3, 1, 4)
        q, k, v = qkv[0], qkv[1], qkv[2]
        scale = Dh ** -0.5
        scores = torch.einsum("bhqd,bhkd->bhqk", q, k) * scale
        p = _softmax(scores, axis=-1)
        o = torch.einsum("bhqk,bhkd->bhqd", p, v)
        return (lambda x, *d: x.permute(*d))(o, 0, 2, 1, 3).reshape(B, S, D) @ wo

    a = _A_ref(A_u, A_log_A_real, A_A_imag, A_C_real, A_C_imag, A_log_dt, A_D_skip)
    b = _B_ref(B_x, B_wqkv, B_wo)
    return torch.concatenate([a, b], axis=-1)
```

```asm
; @launch grid=(256,1,1) block=(512,1,1) lds=163840
.amdgcn_target "amdgcn-amd-amdhsa--gfx950"
.text
.globl concat_heads__ssm_conv_s4d__softmax_full_mha__prompt_kernel
.p2align 12
.fill 832, 4, 0xbf810000
.p2align 8
.type concat_heads__ssm_conv_s4d__softmax_full_mha__prompt_kernel,@function
concat_heads__ssm_conv_s4d__softmax_full_mha__prompt_kernel:
    s_cmp_ge_u32 s2, 256
    s_cbranch_scc1 L_end
    s_load_dwordx16 s[4:19], s[0:1], 0
    s_load_dwordx8 s[20:27], s[0:1], 64
    s_load_dwordx2 s[28:29], s[0:1], 96
    v_lshrrev_b32 v2, 6, v0
    v_and_b32 v0, 63, v0
    v_readfirstlane_b32 s30, v2
    v_lshlrev_b32 v2, 2, v2
    v_mov_b32 v1, 0
    ds_write2_b32 v2, v1, v1 offset1:8
    v_and_b32 v3, 3, v0
    v_lshlrev_b32 v3, 2, v3
    s_and_b32 s60, s2, 7
    s_lshr_b32 s35, s2, 3
    s_and_b32 s32, s35, 1
    s_lshr_b32 s34, s2, 4
    s_lshl1_add_u32 s36, s60, s32
    s_lshl1_add_u32 s61, s60, s34
    s_and_b32 s61, s61, 15
    s_mul_i32 s60, s60, 14
    s_add_u32 s60, s60, s61
    s_lshl1_add_u32 s39, s60, s32
    s_lshr_b32 s33, s60, 4
    s_cmp_ge_u32 s61, 14
    s_cselect_b32 s33, 7, s33
    s_and_b32 s31, s30, 3
    s_mov_b32 s56, 0x40000
    s_mov_b32 s57, 32768
    s_cmp_lt_u32 s30, 4
    s_cbranch_scc1 L_mha
    s_cmp_eq_u32 s33, 7
    s_cbranch_scc1 L_ssm_idle
    s_lshr_b32 s63, s31, 1
    s_lshl_b32 s60, s39, 1
    s_add_u32 s61, s60, s63
    s_mul_i32 s64, s31, 10944
    s_add_u32 s64, s64, 1024
    s_lshl1_add_u32 s65, s60, s31
    s_lshl_b32 s65, s65, 8
    v_lshl_add_u32 v5, v0, 2, s65
    s_mov_b32 m0, s64
    s_mul_i32 s67, s32, 7
    s_add_u32 s67, s67, s33
    s_mul_i32 s68, s34, 14
    s_add_u32 s68, s68, s67
    s_cmp_eq_u32 s31, 1
    s_cbranch_scc1 L_pf1
    s_cmp_eq_u32 s31, 2
    s_cbranch_scc1 L_pf2
    s_mul_i32 s66, s68, 64
    s_mul_hi_u32 s66, s66, 613566757
    s_cmp_eq_u32 s31, 0
    s_cselect_b32 s71, 43, 64
    s_cselect_b32 s67, 6, 4
    s_cselect_b32 s72, 60, 0
    v_mul_u32_u24 v6, s71, v0
    v_lshrrev_b32 v6, 8, v6
    v_mul_u32_u24 v7, s67, v6
    v_sub_u32 v7, v7, v0
    v_add_u32 v6, s66, v6
    v_mul_u32_u24 v6, 7, v6
    v_add3_u32 v8, v6, v7, 6
    s_mov_b32 s46, 1835008
    s_branch L_pf3
    s_nop 0
L_pf1:
    s_mul_i32 s66, s34, 20
    s_add_u32 s66, s66, 128
    v_add_u32 v6, s66, v0
    v_mul_u32_u24 v6, 21, v6
    v_add3_u32 v8, v6, s67, 7
    s_mov_b32 s72, 20
    s_mov_b32 s46, 1204224
    s_branch L_pf3
L_pf2:
    v_mul_u32_u24 v6, 37, v0
    v_lshrrev_b32 v6, 8, v6
    v_mul_u32_u24 v6, 14, v6
    s_mul_i32 s66, s68, 42
    v_add3_u32 v8, v6, v0, s66
    s_mov_b32 s72, 14
    s_mov_b32 s46, 1204224
L_pf3:
    v_lshlrev_b32 v8, 7, v8
    v_cmp_gt_u32 vcc, s72, v0
    s_mov_b32 s47, 0x20000
    v_bfrev_b32 v6, 1
    v_cndmask_b32_e64 v8, v6, v8, vcc
    s_lshl_b32 s66, s60, 1
    s_waitcnt lgkmcnt(0)
    s_load_dword s67, s[14:15], s66
    s_load_dword s68, s[16:17], s66
    global_load_dword v10, v5, s[6:7]
    global_load_dword v11, v5, s[8:9]
    global_load_dword v12, v5, s[10:11]
    global_load_dword v13, v5, s[12:13]
    global_load_dword v14, v1, s[28:29]
    s_cmp_eq_u32 s31, 0
    s_cselect_b64 s[44:45], s[18:19], s[20:21]
    s_cmp_eq_u32 s31, 3
    s_cselect_b64 s[44:45], s[4:5], s[44:45]
    buffer_load_dword v15, v8, s[44:47], 0 offen
    s_barrier
    s_branch L_ssm
L_mha:
    s_cmp_eq_u32 s33, 7
    s_cbranch_scc1 L_tmha
L_mha_b:
    s_setprio 2
    s_mul_i32 s38, s36, 7
    s_lshr_b32 s38, s38, 1
    v_lshrrev_b32 v24, 3, v0
    v_and_b32 v25, 7, v0
    v_lshlrev_b32 v26, 1, v24
    v_and_b32 v26, 4, v26
    v_xor_b32 v26, v26, v25
    v_lshlrev_b32 v26, 4, v26
    v_mul_u32_u24 v5, 2688, v24
    v_add_u32 v5, v5, v26
    v_add_u32 v6, 20480, v5
    v_lshrrev_b32 v26, 1, v24
    v_xor_b32 v26, v26, v25
    v_lshlrev_b32 v26, 4, v26
    v_mul_u32_u24 v24, 896, v24
    v_add_u32 v7, v24, v26
    v_xor_b32 v26, 64, v26
    v_add_u32 v8, v24, v26
    v_add_u32 v8, 6144, v8
    v_add_u32 v9, 12288, v7
    v_add_u32 v10, 12288, v8
    s_lshl2_add_u32 s60, s34, s31
    s_lshl3_add_u32 s70, s32, s33
    s_lshl_b32 s70, s70, 6
    s_add_u32 s70, s70, s34
    s_lshl_b32 s70, s70, 7
    s_add_u32 s70, s70, 4096
    s_mul_i32 s60, s60, 28672
    s_mul_i32 s61, s32, 7
    s_add_u32 s61, s61, s33
    s_add_u32 s61, s61, 7
    s_lshl_b32 s61, s61, 7
    s_mul_i32 s65, s31, 43008
    s_add_u32 s61, s61, s65
    s_mul_i32 s64, s31, 12288
    s_add_u32 s64, s64, 114688
    s_lshl_b32 s68, s31, 11
    s_add_u32 s68, s68, 57344
    s_mov_b32 s46, 1835008
    s_mov_b32 s47, 0x20000
    s_mov_b32 s50, 1204224
    s_mov_b32 s51, 0x20000
    s_mov_b32 m0, s64
    s_waitcnt lgkmcnt(0)
    s_mov_b64 s[44:45], s[18:19]
    s_mov_b64 s[48:49], s[20:21]
    s_load_dword s37, s[28:29], 0
    s_cmp_eq_u32 s33, 7
    s_cbranch_scc1 L_gemm_t
    s_barrier
    buffer_load_dwordx4 v7, s[44:47], s60 offen offset:0 lds
    buffer_load_dwordx4 v8, s[44:47], s60 offen offset:1024 lds
    buffer_load_dwordx4 v9, s[44:47], s60 offen offset:2048 lds
    buffer_load_dwordx4 v10, s[44:47], s60 offen offset:3072 lds
    s_mov_b64 exec, 0
    s_cmp_eq_u32 s31, 0
    s_cbranch_scc1 L_sp0
    s_cmp_eq_u32 s31, 1
    s_cbranch_scc1 L_sp1
    s_cmp_eq_u32 s31, 2
    s_cbranch_scc1 L_sp2
    s_branch L_sp3
L_tmha:
    s_and_b32 s65, s35, 3
    s_lshl2_add_u32 s65, s65, s31
    s_mov_b64 exec, 0
    s_cmp_eq_u32 s65, 0
    s_cbranch_scc1 L_pad0
    s_cmp_eq_u32 s65, 1
    s_cbranch_scc1 L_pad1
    s_cmp_eq_u32 s65, 2
    s_cbranch_scc1 L_pad2
    s_cmp_eq_u32 s65, 3
    s_cbranch_scc1 L_pad3
    s_cmp_eq_u32 s65, 4
    s_cbranch_scc1 L_pad4
    s_cmp_eq_u32 s65, 5
    s_cbranch_scc1 L_pad5
    s_cmp_eq_u32 s65, 6
    s_cbranch_scc1 L_pad6
    s_cmp_eq_u32 s65, 7
    s_cbranch_scc1 L_pad7
    s_cmp_eq_u32 s65, 8
    s_cbranch_scc1 L_pad8
    s_cmp_eq_u32 s65, 9
    s_cbranch_scc1 L_pad9
    s_cmp_eq_u32 s65, 10
    s_cbranch_scc1 L_pad10
    s_cmp_eq_u32 s65, 11
    s_cbranch_scc1 L_pad11
    s_cmp_eq_u32 s65, 12
    s_cbranch_scc1 L_pad12
    s_cmp_eq_u32 s65, 13
    s_cbranch_scc1 L_pad13
    s_cmp_eq_u32 s65, 14
    s_cbranch_scc1 L_pad14
    s_cmp_eq_u32 s65, 15
    s_cbranch_scc1 L_pad15
L_pad_ret:
    s_mov_b64 exec, -1
    s_branch L_mha_b
    s_nop 0
L_ssm:
    s_setprio 1
    s_mov_b64 s[40:41], s[28:29]
    s_mov_b32 s42, 16777216
    s_mov_b32 s43, 0x20000
    s_and_b32 s62, s31, 1
    v_add_u32 v3, 16, v3
    v_and_b32 v5, 15, v0
    v_lshrrev_b32 v6, 4, v0
    v_lshl_add_u32 v21, v6, 4, s64
    v_mul_u32_u24 v7, 288, v5
    v_add_u32 v20, v7, v21
    v_lshlrev_b32 v230, 4, v0
    v_mov_b32 v56, 0x3c00
    ds_write_addtid_b32 v56
    v_mov_b64 v[40:41], 0
    v_mov_b64 v[42:43], 0
    v_mov_b64 v[44:45], 0
    v_mov_b64 v[46:47], 0
    v_mov_b64 v[48:49], 0
    v_mov_b64 v[50:51], 0
    v_mov_b64 v[52:53], 0
    v_mov_b64 v[54:55], 0
    v_and_b32_e64 v5, 7, v0
    s_and_b32 s66, s2, 7
    s_lshl2_add_u32 s66, s66, s31
    s_mul_i32 s66, s66, 1024
    s_add_u32 s66, s66, 266240
    v_mul_u32_u24 v26, 128, v5
    v_add_u32_e64 v26, s66, v26
    s_mul_i32 s85, s63, 21888
    s_add_u32 s85, s85, 1024
    s_add_u32 s87, s85, 12480
    s_lshl_b32 s66, s62, 8
    s_add_u32 s71, s66, s87
    s_add_u32 s65, s71, 1216
    v_lshl_add_u32 v33, v5, 4, s65
    v_mov_b32 v37, s87
    v_and_b32 v5, 15, v0
    v_lshrrev_b32 v6, 4, v0
    s_lshl_b32 s65, s62, 4
    v_add_u32 v5, s65, v5
    v_and_b32 v9, 1, v0
    v_mul_u32_u24 v7, 255, v9
    v_sub_u32 v7, v7, v5
    s_add_u32 s65, s87, 1120
    v_add_u32 v24, s65, v7
    v_add_u32 v25, 96, v24
    s_lshl3_add_u32 s65, s63, 16
    v_lshl_add_u32 v32, v9, 2, s65
    s_mul_i32 s65, s62, 176
    s_add_u32 s65, s65, s87
    s_add_u32 s65, s65, 1024
    v_writelane_b32 v25, s65, 0
    s_mul_i32 s65, s62, 56
    s_sub_u32 s65, s87, s65
    s_add_u32 s65, s65, 1088
    v_writelane_b32 v25, s65, 16
    v_max_u32 v7, 1, v6
    v_sub_u32 v7, 5, v7
    v_lshlrev_b32 v5, v7, v5
    v_lshlrev_b32 v7, 3, v6
    s_mov_b32 s65, 0x60400100
    v_bfe_u32 v6, s65, v7, 8
    v_lshl_add_u32 v5, v6, 3, v5
    v_add_u32 v22, s87, v5
    s_mov_b32 s65, 0x80040404
    v_bfe_u32 v6, s65, v7, 8
    v_add_u32 v23, v6, v22
    v_lshrrev_b32 v6, 1, v0
    v_lshlrev_b32 v224, 6, v6
    v_lshl_add_u32 v224, v9, 4, v224
    s_lshr_b32 s65, s60, 2
    s_mul_i32 s65, s65, 16384
    s_and_b32 s66, s60, 3
    s_lshl4_add_u32 s65, s66, s65
    s_lshl_b32 s66, s31, 12
    s_add_u32 s65, s65, s66
    s_add_u32 s74, s65, 7340032
    v_and_b32 v6, 3, v6
    v_lshl_add_u32 v6, v9, 2, v6
    v_mul_u32_u24 v6, 1552, v6
    v_lshrrev_b32 v7, 3, v0
    v_lshl_add_u32 v6, v7, 4, v6
    s_lshl_b32 s65, s31, 8
    s_add_u32 s65, s65, 45312
    v_add_u32 v228, s65, v6
    v_lshrrev_b32 v6, 5, v0
    s_lshl_b32 s65, s62, 1
    v_max_u32 v5, s65, v6
    v_min_u32 v7, 1, v5
    v_mul_u32_u24 v7, 0x0202, v7
    v_lshlrev_b32 v7, 16, v7
    v_sub_u32 v180, 0x03020100, v7
    v_mul_u32_u24 v7, 0x0202, v5
    v_lshl_or_b32 v7, v7, 16, v7
    v_sub_u32 v181, 0x07060504, v7
    s_mul_i32 s65, s62, 0x02020202
    v_add_u32 v182, s65, v180
    s_mul_i32 s65, s62, 0x02020404
    v_add_u32 v183, s65, v181
    v_lshrrev_b32 v7, v5, v230
    s_movk_i32 s65, 256
    v_lshl_add_u32 v7, s65, v5, v7
    s_sub_u32 s65, s87, 256
    v_add_u32 v27, s65, v7
    v_lshlrev_b32 v7, 2, v5
    v_sub_u32_e64 v28, v27, v7
    s_mov_b32 s65, 0x0c0c0c0c
    s_cmp_lg_u32 s62, 0
    s_cselect_b32 s84, 0x01000100, s65
    s_cselect_b32 s86, 0x05040302, s65
    v_mov_b32 v184, s65
    v_mov_b32 v185, s65
    v_mov_b32 v186, s65
    v_mov_b32 v187, s65
    s_mov_b32 s65, 0x05040504
    s_mov_b64 exec, 15
    v_mov_b32 v184, s65
    v_mov_b32 v185, s65
    v_mov_b32 v186, s65
    s_mov_b64 exec, -1
    v_writelane_b32 v187, s65, 3
    s_mov_b32 s65, 0x05040302
    v_writelane_b32 v184, s65, 3
    s_mov_b32 s65, 0x0c0c0504
    v_writelane_b32 v186, s65, 0
    v_writelane_b32 v187, s65, 2
    s_mul_i32 s65, s31, 3104
    s_add_u32 s65, s65, 44800
    v_mul_u32_u24 v7, 1040, v6
    v_add3_u32 v226, v7, v230, s65
    v_mov_b64 v[220:221], 0
    v_mov_b64 v[222:223], 0
    ds_write_b128 v226, v[220:223]
    s_lshl_b32 s65, s62, 10
    s_add_u32 s66, s85, 1536
    s_add_u32 s65, s65, s66
    s_add_u32 s65, s65, 64
    v_add_u32 v225, s65, v230
    v_and_b32 v9, 3, v0
    v_and_b32 v5, 0x1c, v0
    v_lshlrev_b32 v7, 2, v5
    v_and_b32 v227, 0x30, v7
    s_mov_b32 exec_hi, 0
    v_add_u32 v227, 2112, v7
    s_mov_b64 exec, -1
    v_mul_u32_u24 v7, 2240, v9
    v_add3_u32 v227, v227, v7, s66
    v_lshlrev_b32 v5, 1, v5
    v_sub_u32 v5, v5, v7
    v_lshlrev_b32 v6, 4, v6
    v_sub_u32 v5, v5, v6
    s_lshl_b32 s65, s62, 5
    s_sub_u32 s66, s66, s65
    s_add_u32 s66, s66, 6776
    v_add_u32 v229, s66, v5
    v_add_u32 v226, -16, v226
    v_add_u32 v30, s64, v230
    s_xor_b32 s65, s31, 1
    s_mul_i32 s65, s65, 10944
    s_add_u32 s65, s65, 1024
    v_add_u32 v31, s65, v230
    v_and_b32 v5, 31, v0
    v_lshlrev_b32 v7, 2, v5
    v_sub_u32 v7, v6, v7
    s_add_u32 s65, s71, 1212
    v_add_u32 v34, s65, v7
    s_waitcnt lgkmcnt(0)
    s_lshl_b32 s65, s63, 4
    s_lshr_b32 s67, s67, s65
    s_lshl_b32 s67, s67, 16
    s_lshr_b32 s68, s68, s65
    s_lshl_b32 s68, s68, 16
    v_mov_b32 v5, s67
    v_mul_f32 v5, 0x3fb8aa3b, v5
    v_exp_f32_e64 v5, v5
    s_cmp_eq_u32 s62, 0
    s_cselect_b32 s68, s68, 0
    v_cvt_pk_bf16_f32 v5, v5, v5
    v_and_b32 v57, 0xffff0000, v5
    v_mul_f32 v18, 0xbfb8aa3b, v57
    v_mul_f32 v19, 0.15915494, v57
    v_mov_b32 v58, 0
    v_add_f32 v57, v57, v57
    v_writelane_b32 v58, s68, 0
    s_mov_b32 s69, 0
    s_mov_b32 s73, 0x01000c0c
    s_waitcnt vmcnt(2)
    v_and_b32 v5, 0x7f807f80, v12
    v_and_b32 v6, 0x7f807f80, v13
    v_pk_max_u16 v5, v5, v6
    v_lshlrev_b32 v6, 16, v5
    v_max_u32 v5, v5, v6
    s_nop 1
    v_max_u32_dpp v5, v5, v5 row_ror:1 row_mask:0xf bank_mask:0xf
    s_nop 1
    v_max_u32_dpp v5, v5, v5 row_ror:2 row_mask:0xf bank_mask:0xf
    s_nop 1
    v_max_u32_dpp v5, v5, v5 row_ror:4 row_mask:0xf bank_mask:0xf
    s_nop 1
    v_max_u32_dpp v5, v5, v5 row_ror:8 row_mask:0xf bank_mask:0xf
    s_nop 0
    v_readlane_b32 s65, v5, 0
    v_readlane_b32 s66, v5, 16
    v_readlane_b32 s71, v5, 32
    v_readlane_b32 s72, v5, 48
    s_max_u32 s65, s65, s66
    s_max_u32 s72, s72, s71
    s_max_u32 s72, s72, s65
    s_and_b32 s72, s72, 0x7f800000
    s_min_u32 s72, s72, 0x7e800000
    s_sub_u32 s71, 0x7f000000, s72
    v_mul_f32 v57, s72, v57
    v_mul_f32 v38, 0x43000000, v57
    v_mov_b32 v39, v38
    s_mov_b64 exec, 1
    v_mov_b32 v39, v57
    s_mov_b64 exec, -1
L_kg:
    v_perm_b32 v200, v10, v10, s73
    v_mul_f32 v200, 0x3fb8aa3b, v200
    v_exp_f32_e64 v200, v200
    v_perm_b32 v201, v11, v11, s73
    v_perm_b32 v196, v12, v12, s73
    v_perm_b32 v197, v13, v13, s73
    v_cvt_pk_bf16_f32 v200, v200, v200
    v_mul_f32 v196, s71, v196
    v_and_b32 v200, 0xffff0000, v200
    v_mul_f32 v197, s71, v197
    v_pk_mul_f32 v[200:201], v[200:201], v[18:19]
    v_cvt_pk_f16_f32 v144, v196, -v197
    v_mul_f32 v202, 0x42800000, v200
    v_mul_f32 v203, 0x42800000, v201
    v_exp_f32 v200, v200
    v_fract_f32 v201, v201
    v_exp_f32 v202, v202
    v_fract_f32 v203, v203
    v_cos_f32 v192, v201
    v_sin_f32 v193, v201
    v_cos_f32 v194, v203
    v_sin_f32 v195, v203
    v_pk_mul_f32 v[192:193], v[192:193], v[200:201] op_sel_hi:[1,0]
    v_pk_mul_f32 v[194:195], v[194:195], v[202:203] op_sel_hi:[1,0]
    v_pk_mul_f32 v[196:197], v[192:193], v[192:193] op_sel_hi:[0,1]
    v_pk_mul_f32 v[198:199], v[194:195], v[194:195] op_sel_hi:[0,1]
    v_cvt_pk_f16_f32 v166, v192, v193
    v_cvt_pk_f16_f32 v136, v194, v195
    v_pk_fma_f32 v[192:193], v[192:193], v[192:193], v[196:197] op_sel:[1,1,0] op_sel_hi:[0,1,1] neg_lo:[1,0,0]
    v_pk_fma_f32 v[194:195], v[194:195], v[194:195], v[198:199] op_sel:[1,1,0] op_sel_hi:[0,1,1] neg_lo:[1,0,0]
    v_pk_mul_f32 v[196:197], v[192:193], v[192:193] op_sel_hi:[0,1]
    v_pk_mul_f32 v[198:199], v[194:195], v[194:195] op_sel_hi:[0,1]
    v_cvt_pk_f16_f32 v167, v192, v193
    v_cvt_pk_f16_f32 v165, v194, v195
    v_pk_fma_f32 v[192:193], v[192:193], v[192:193], v[196:197] op_sel:[1,1,0] op_sel_hi:[0,1,1] neg_lo:[1,0,0]
    v_pk_fma_f32 v[194:195], v[194:195], v[194:195], v[198:199] op_sel:[1,1,0] op_sel_hi:[0,1,1] neg_lo:[1,0,0]
    v_pk_mul_f32 v[196:197], v[192:193], v[192:193] op_sel_hi:[0,1]
    v_pk_mul_f32 v[198:199], v[194:195], v[194:195] op_sel_hi:[0,1]
    v_cvt_pk_f16_f32 v168, v192, v193
    v_cvt_pk_f16_f32 v169, v194, v195
    v_pk_fma_f32 v[192:193], v[192:193], v[192:193], v[196:197] op_sel:[1,1,0] op_sel_hi:[0,1,1] neg_lo:[1,0,0]
    v_pk_fma_f32 v[194:195], v[194:195], v[194:195], v[198:199] op_sel:[1,1,0] op_sel_hi:[0,1,1] neg_lo:[1,0,0]
    v_pk_mul_f32 v[196:197], v[192:193], v[192:193] op_sel_hi:[0,1]
    v_pk_mul_f32 v[198:199], v[194:195], v[194:195] op_sel_hi:[0,1]
    v_cvt_pk_f16_f32 v129, v192, v193
    v_cvt_pk_f16_f32 v170, v194, v195
    v_pk_fma_f32 v[192:193], v[192:193], v[192:193], v[196:197] op_sel:[1,1,0] op_sel_hi:[0,1,1] neg_lo:[1,0,0]
    v_pk_fma_f32 v[194:195], v[194:195], v[194:195], v[198:199] op_sel:[1,1,0] op_sel_hi:[0,1,1] neg_lo:[1,0,0]
    v_pk_mul_f32 v[196:197], v[192:193], v[192:193] op_sel_hi:[0,1]
    v_cvt_pk_f16_f32 v130, v192, v193
    v_cvt_pk_f16_f32 v171, v194, v195
    v_pk_fma_f32 v[192:193], v[192:193], v[192:193], v[196:197] op_sel:[1,1,0] op_sel_hi:[0,1,1] neg_lo:[1,0,0]
    v_cvt_pk_f16_f32 v132, v192, v193
    v_pk_mul_f16 v145, v144, v166 op_sel_hi:[1,0]
    v_pk_mul_f16 v146, v144, v167 op_sel_hi:[1,0]
    v_pk_mul_f16 v148, v144, v168 op_sel_hi:[1,0]
    v_pk_mul_f16 v152, v144, v169 op_sel_hi:[1,0]
    v_pk_mul_f16 v156, v144, v170 op_sel_hi:[1,0]
    v_pk_mul_f16 v160, v144, v171 op_sel_hi:[1,0]
    v_pk_fma_f16 v145, v144, v166, v145 op_sel:[1,1,0] op_sel_hi:[0,1,1] neg_hi:[1,0,0]
    v_pk_fma_f16 v146, v144, v167, v146 op_sel:[1,1,0] op_sel_hi:[0,1,1] neg_hi:[1,0,0]
    v_pk_fma_f16 v148, v144, v168, v148 op_sel:[1,1,0] op_sel_hi:[0,1,1] neg_hi:[1,0,0]
    v_pk_fma_f16 v152, v144, v169, v152 op_sel:[1,1,0] op_sel_hi:[0,1,1] neg_hi:[1,0,0]
    v_pk_fma_f16 v156, v144, v170, v156 op_sel:[1,1,0] op_sel_hi:[0,1,1] neg_hi:[1,0,0]
    v_pk_fma_f16 v160, v144, v171, v160 op_sel:[1,1,0] op_sel_hi:[0,1,1] neg_hi:[1,0,0]
    v_pk_mul_f16 v131, v129, v130 op_sel_hi:[1,0]
    v_pk_mul_f16 v140, v132, v136 op_sel_hi:[1,0]
    v_pk_mul_f16 v133, v132, v129 op_sel_hi:[1,0]
    v_pk_mul_f16 v134, v132, v130 op_sel_hi:[1,0]
    v_pk_mul_f16 v137, v136, v129 op_sel_hi:[1,0]
    v_pk_mul_f16 v138, v136, v130 op_sel_hi:[1,0]
    v_pk_fma_f16 v131, v129, v130, v131 op_sel:[1,1,0] op_sel_hi:[0,1,1] neg_lo:[1,0,0]
    v_pk_fma_f16 v140, v132, v136, v140 op_sel:[1,1,0] op_sel_hi:[0,1,1] neg_lo:[1,0,0]
    v_pk_fma_f16 v133, v132, v129, v133 op_sel:[1,1,0] op_sel_hi:[0,1,1] neg_lo:[1,0,0]
    v_pk_fma_f16 v134, v132, v130, v134 op_sel:[1,1,0] op_sel_hi:[0,1,1] neg_lo:[1,0,0]
    v_pk_fma_f16 v137, v136, v129, v137 op_sel:[1,1,0] op_sel_hi:[0,1,1] neg_lo:[1,0,0]
    v_pk_fma_f16 v138, v136, v130, v138 op_sel:[1,1,0] op_sel_hi:[0,1,1] neg_lo:[1,0,0]
    v_pk_mul_f16 v147, v145, v167 op_sel_hi:[1,0]
    v_pk_mul_f16 v149, v145, v168 op_sel_hi:[1,0]
    v_pk_mul_f16 v150, v146, v168 op_sel_hi:[1,0]
    v_pk_mul_f16 v153, v146, v169 op_sel_hi:[1,0]
    v_pk_mul_f16 v154, v148, v169 op_sel_hi:[1,0]
    v_pk_mul_f16 v157, v148, v170 op_sel_hi:[1,0]
    v_pk_mul_f16 v158, v152, v170 op_sel_hi:[1,0]
    v_pk_mul_f16 v161, v152, v171 op_sel_hi:[1,0]
    v_pk_mul_f16 v162, v156, v171 op_sel_hi:[1,0]
    v_pk_mul_f16 v164, v160, v171 op_sel_hi:[1,0]
    v_pk_fma_f16 v147, v145, v167, v147 op_sel:[1,1,0] op_sel_hi:[0,1,1] neg_hi:[1,0,0]
    v_pk_fma_f16 v149, v145, v168, v149 op_sel:[1,1,0] op_sel_hi:[0,1,1] neg_hi:[1,0,0]
    v_pk_fma_f16 v150, v146, v168, v150 op_sel:[1,1,0] op_sel_hi:[0,1,1] neg_hi:[1,0,0]
    v_pk_fma_f16 v153, v146, v169, v153 op_sel:[1,1,0] op_sel_hi:[0,1,1] neg_hi:[1,0,0]
    v_pk_fma_f16 v154, v148, v169, v154 op_sel:[1,1,0] op_sel_hi:[0,1,1] neg_hi:[1,0,0]
    v_pk_fma_f16 v157, v148, v170, v157 op_sel:[1,1,0] op_sel_hi:[0,1,1] neg_hi:[1,0,0]
    v_pk_fma_f16 v158, v152, v170, v158 op_sel:[1,1,0] op_sel_hi:[0,1,1] neg_hi:[1,0,0]
    v_pk_fma_f16 v161, v152, v171, v161 op_sel:[1,1,0] op_sel_hi:[0,1,1] neg_hi:[1,0,0]
    v_pk_fma_f16 v162, v156, v171, v162 op_sel:[1,1,0] op_sel_hi:[0,1,1] neg_hi:[1,0,0]
    v_pk_fma_f16 v164, v160, v171, v164 op_sel:[1,1,0] op_sel_hi:[0,1,1] neg_hi:[1,0,0]
    v_pk_mul_f16 v135, v132, v131 op_sel_hi:[1,0]
    v_pk_mul_f16 v139, v136, v131 op_sel_hi:[1,0]
    v_pk_mul_f16 v141, v140, v129 op_sel_hi:[1,0]
    v_pk_mul_f16 v142, v140, v130 op_sel_hi:[1,0]
    v_pk_mul_f16 v143, v140, v131 op_sel_hi:[1,0]
    v_pk_fma_f16 v135, v132, v131, v135 op_sel:[1,1,0] op_sel_hi:[0,1,1] neg_lo:[1,0,0]
    v_pk_fma_f16 v139, v136, v131, v139 op_sel:[1,1,0] op_sel_hi:[0,1,1] neg_lo:[1,0,0]
    v_pk_fma_f16 v141, v140, v129, v141 op_sel:[1,1,0] op_sel_hi:[0,1,1] neg_lo:[1,0,0]
    v_pk_fma_f16 v142, v140, v130, v142 op_sel:[1,1,0] op_sel_hi:[0,1,1] neg_lo:[1,0,0]
    v_pk_fma_f16 v143, v140, v131, v143 op_sel:[1,1,0] op_sel_hi:[0,1,1] neg_lo:[1,0,0]
    v_pk_mul_f16 v151, v147, v168 op_sel_hi:[1,0]
    v_pk_mul_f16 v155, v150, v169 op_sel_hi:[1,0]
    v_pk_mul_f16 v159, v154, v170 op_sel_hi:[1,0]
    v_pk_mul_f16 v163, v158, v171 op_sel_hi:[1,0]
    v_pk_fma_f16 v151, v147, v168, v151 op_sel:[1,1,0] op_sel_hi:[0,1,1] neg_hi:[1,0,0]
    v_pk_fma_f16 v155, v150, v169, v155 op_sel:[1,1,0] op_sel_hi:[0,1,1] neg_hi:[1,0,0]
    v_pk_fma_f16 v159, v154, v170, v159 op_sel:[1,1,0] op_sel_hi:[0,1,1] neg_hi:[1,0,0]
    v_pk_fma_f16 v163, v158, v171, v163 op_sel:[1,1,0] op_sel_hi:[0,1,1] neg_hi:[1,0,0]
    s_setprio 3
    s_nop 0
    ds_write_addtid_b32 v129 offset:288
    ds_write_addtid_b32 v130 offset:576
    ds_write_addtid_b32 v131 offset:864
    ds_write_addtid_b32 v132 offset:1152
    ds_write_addtid_b32 v133 offset:1440
    ds_write_addtid_b32 v134 offset:1728
    ds_write_addtid_b32 v135 offset:2016
    ds_write_addtid_b32 v136 offset:2304
    ds_write_addtid_b32 v137 offset:2592
    ds_write_addtid_b32 v138 offset:2880
    ds_write_addtid_b32 v139 offset:3168
    ds_write_addtid_b32 v140 offset:3456
    ds_write_addtid_b32 v141 offset:3744
    ds_write_addtid_b32 v142 offset:4032
L_pad14:
    s_cbranch_execz L_pad_ret
    s_nop 0
    ds_write_addtid_b32 v143 offset:4320
    ds_write_addtid_b32 v144 offset:4608
    ds_write_addtid_b32 v145 offset:4896
    ds_write_addtid_b32 v146 offset:5184
    ds_write_addtid_b32 v147 offset:5472
    ds_write_addtid_b32 v148 offset:5760
    ds_write_addtid_b32 v149 offset:6048
    ds_write_addtid_b32 v150 offset:6336
    ds_write_addtid_b32 v151 offset:6624
    ds_write_addtid_b32 v152 offset:6912
    ds_write_addtid_b32 v153 offset:7200
    ds_write_addtid_b32 v154 offset:7488
    ds_write_addtid_b32 v155 offset:7776
    ds_write_addtid_b32 v156 offset:8064
    ds_write_addtid_b32 v157 offset:8352
    ds_write_addtid_b32 v158 offset:8640
    ds_write_addtid_b32 v159 offset:8928
    ds_write_addtid_b32 v160 offset:9216
    ds_write_addtid_b32 v161 offset:9504
    ds_write_addtid_b32 v162 offset:9792
    ds_write_addtid_b32 v163 offset:10080
    ds_write_addtid_b32 v164 offset:10368
    ds_write_addtid_b32 v165 offset:10656
    ds_read_b128 v[64:67], v20 offset:0
    ds_read_b128 v[68:71], v21 offset:10656
    ds_read_b128 v[72:75], v20 offset:4608
    ds_read_b128 v[76:79], v20 offset:9216
    ds_read_b128 v[80:83], v20 offset:64
    ds_read_b128 v[84:87], v21 offset:10720
    ds_read_b128 v[88:91], v20 offset:4672
    ds_read_b128 v[92:95], v20 offset:9280
    ds_read_b128 v[96:99], v20 offset:128
    ds_read_b128 v[100:103], v21 offset:10784
    ds_read_b128 v[104:107], v20 offset:4736
    ds_read_b128 v[108:111], v20 offset:9344
    ds_read_b128 v[112:115], v20 offset:192
    ds_read_b128 v[116:119], v21 offset:10848
    ds_read_b128 v[120:123], v20 offset:4800
    ds_read_b128 v[124:127], v20 offset:9408
    s_waitcnt lgkmcnt(12)
    v_mfma_f32_16x16x32_f16 v[40:43], v[72:75], v[64:67], v[40:43]
    v_pk_mul_f16 v172, v64, v68 op_sel_hi:[1,0]
    v_pk_mul_f16 v173, v65, v69 op_sel_hi:[1,0]
    v_pk_mul_f16 v174, v66, v70 op_sel_hi:[1,0]
    v_pk_mul_f16 v175, v67, v71 op_sel_hi:[1,0]
    v_mfma_f32_16x16x32_f16 v[44:47], v[76:79], v[64:67], v[44:47]
    v_pk_fma_f16 v172, v64, v68, v172 op_sel:[1,1,0] op_sel_hi:[0,1,1] neg_lo:[1,0,0]
    v_pk_fma_f16 v173, v65, v69, v173 op_sel:[1,1,0] op_sel_hi:[0,1,1] neg_lo:[1,0,0]
    v_pk_fma_f16 v174, v66, v70, v174 op_sel:[1,1,0] op_sel_hi:[0,1,1] neg_lo:[1,0,0]
    v_pk_fma_f16 v175, v67, v71, v175 op_sel:[1,1,0] op_sel_hi:[0,1,1] neg_lo:[1,0,0]
    s_waitcnt lgkmcnt(8)
    v_mfma_f32_16x16x32_f16 v[40:43], v[88:91], v[80:83], v[40:43]
    v_pk_mul_f16 v176, v80, v84 op_sel_hi:[1,0]
    v_pk_mul_f16 v177, v81, v85 op_sel_hi:[1,0]
    v_mfma_f32_16x16x32_f16 v[48:51], v[72:75], v[172:175], v[48:51]
    v_pk_mul_f16 v178, v82, v86 op_sel_hi:[1,0]
    v_pk_mul_f16 v179, v83, v87 op_sel_hi:[1,0]
    v_mfma_f32_16x16x32_f16 v[44:47], v[92:95], v[80:83], v[44:47]
    v_pk_fma_f16 v176, v80, v84, v176 op_sel:[1,1,0] op_sel_hi:[0,1,1] neg_lo:[1,0,0]
    v_pk_fma_f16 v177, v81, v85, v177 op_sel:[1,1,0] op_sel_hi:[0,1,1] neg_lo:[1,0,0]
    v_mfma_f32_16x16x32_f16 v[52:55], v[76:79], v[172:175], v[52:55]
    v_pk_fma_f16 v178, v82, v86, v178 op_sel:[1,1,0] op_sel_hi:[0,1,1] neg_lo:[1,0,0]
    v_pk_fma_f16 v179, v83, v87, v179 op_sel:[1,1,0] op_sel_hi:[0,1,1] neg_lo:[1,0,0]
    s_waitcnt lgkmcnt(4)
    s_nop 0
    v_mfma_f32_16x16x32_f16 v[40:43], v[104:107], v[96:99], v[40:43]
    v_pk_mul_f16 v172, v96, v100 op_sel_hi:[1,0]
    v_pk_mul_f16 v173, v97, v101 op_sel_hi:[1,0]
    v_mfma_f32_16x16x32_f16 v[48:51], v[88:91], v[176:179], v[48:51]
    v_pk_mul_f16 v174, v98, v102 op_sel_hi:[1,0]
    v_pk_mul_f16 v175, v99, v103 op_sel_hi:[1,0]
    v_mfma_f32_16x16x32_f16 v[44:47], v[108:111], v[96:99], v[44:47]
    v_pk_fma_f16 v172, v96, v100, v172 op_sel:[1,1,0] op_sel_hi:[0,1,1] neg_lo:[1,0,0]
    v_pk_fma_f16 v173, v97, v101, v173 op_sel:[1,1,0] op_sel_hi:[0,1,1] neg_lo:[1,0,0]
    v_mfma_f32_16x16x32_f16 v[52:55], v[92:95], v[176:179], v[52:55]
    v_pk_fma_f16 v174, v98, v102, v174 op_sel:[1,1,0] op_sel_hi:[0,1,1] neg_lo:[1,0,0]
    v_pk_fma_f16 v175, v99, v103, v175 op_sel:[1,1,0] op_sel_hi:[0,1,1] neg_lo:[1,0,0]
    s_waitcnt lgkmcnt(0)
    s_nop 0
    v_mfma_f32_16x16x32_f16 v[40:43], v[120:123], v[112:115], v[40:43]
    v_pk_mul_f16 v176, v112, v116 op_sel_hi:[1,0]
    v_pk_mul_f16 v177, v113, v117 op_sel_hi:[1,0]
    v_mfma_f32_16x16x32_f16 v[48:51], v[104:107], v[172:175], v[48:51]
    v_pk_mul_f16 v178, v114, v118 op_sel_hi:[1,0]
    v_pk_mul_f16 v179, v115, v119 op_sel_hi:[1,0]
    v_mfma_f32_16x16x32_f16 v[44:47], v[124:127], v[112:115], v[44:47]
    v_pk_fma_f16 v176, v112, v116, v176 op_sel:[1,1,0] op_sel_hi:[0,1,1] neg_lo:[1,0,0]
    v_pk_fma_f16 v177, v113, v117, v177 op_sel:[1,1,0] op_sel_hi:[0,1,1] neg_lo:[1,0,0]
    v_mfma_f32_16x16x32_f16 v[52:55], v[108:111], v[172:175], v[52:55]
    v_pk_fma_f16 v178, v114, v118, v178 op_sel:[1,1,0] op_sel_hi:[0,1,1] neg_lo:[1,0,0]
    v_pk_fma_f16 v179, v115, v119, v179 op_sel:[1,1,0] op_sel_hi:[0,1,1] neg_lo:[1,0,0]
    s_add_u32 s73, s73, 0x02020000
    s_add_u32 s69, s69, 1
    s_cmp_lg_u32 s69, 2
    v_mfma_f32_16x16x32_f16 v[48:51], v[120:123], v[176:179], v[48:51]
    v_mfma_f32_16x16x32_f16 v[52:55], v[124:127], v[176:179], v[52:55]
    s_setprio 1
    s_cbranch_scc1 L_kg
    v_mul_f32 v40, v57, v40
    v_mul_f32 v41, v57, v41
    v_mul_f32 v42, v57, v42
    v_mul_f32 v43, v57, v43
    v_mul_f32 v44, v39, v44
    v_mul_f32 v45, v38, v45
    v_mul_f32 v46, v38, v46
    v_mul_f32 v47, v38, v47
    s_cmp_eq_u32 s62, 0
    v_mul_f32 v48, v57, v48
    v_mul_f32 v49, v57, v49
    v_mul_f32 v50, v57, v50
    v_mul_f32 v51, v57, v51
    v_mul_f32 v52, v38, v52
    v_mul_f32 v53, v38, v53
    v_mul_f32 v54, v38, v54
    v_mul_f32 v55, v38, v55
    s_cbranch_scc1 L_kx
    v_swap_b32 v40, v48
    v_swap_b32 v41, v49
    v_swap_b32 v42, v50
    v_swap_b32 v43, v51
L_sp3:
    s_cbranch_execz L_mha1
    v_swap_b32 v44, v52
    v_swap_b32 v45, v53
    v_swap_b32 v46, v54
    v_swap_b32 v47, v55
L_kx:
    ds_write_b128 v30, v[48:51]
    s_mov_b32 exec_hi, 0
    ds_write_b128 v30, v[52:55] offset:1024
    s_mov_b64 exec, -1
    s_waitcnt vmcnt(0)
    v_readfirstlane_b32 s37, v14
    v_mov_b32 v1, 2
    ds_write_b32 v2, v1
    s_add_u32 s37, s37, 0x9e3779b9
    v_add_f32 v40, v58, v40
    s_setprio 1
L_lw_10:
    ds_read_b32 v1, v32
    s_waitcnt lgkmcnt(0)
    v_cmp_gt_u32 vcc, 2, v1
    s_cbranch_vccnz L_lw_10
    ds_read_b128 v[48:51], v31
    ds_read_b128 v[52:55], v31 offset:1024
    ds_write_b128 v33, v[220:223]
    s_mov_b32 s69, 4
    s_waitcnt lgkmcnt(1)
    v_pk_add_f32 v[40:41], v[40:41], v[48:49]
    v_pk_add_f32 v[42:43], v[42:43], v[50:51]
    v_pk_add_f32 v[44:45], v[44:45], v[52:53]
    v_pk_add_f32 v[46:47], v[46:47], v[54:55]
    v_cvt_pk_bf16_f32 v48, v40, v41
    v_cvt_pk_bf16_f32 v49, v42, v43
    v_cvt_pk_bf16_f32 v50, v44, v45
    v_cvt_pk_bf16_f32 v51, v46, v47
    ds_write_b32 v22, v48
L_pad15:
    s_cbranch_execz L_pad_ret
    ds_write_b32 v23, v49
    s_mov_b64 exec, 0x1ffff
    ds_write_b16 v25, v50
    s_mov_b64 exec, 0xffff
    ds_write_b16_d16_hi v24, v50 offset:64
    ds_write_b16 v24, v51 offset:32
    ds_write_b16_d16_hi v24, v51
    s_mov_b64 exec, -1
    v_mov_b32 v1, 3
    ds_write_b32 v2, v1
    s_setprio 3
    buffer_load_dword v29, v26, s[40:43], 0 offen sc1
    s_setprio 1
L_lw_11:
    ds_read_b32 v1, v32
    s_waitcnt lgkmcnt(0)
    v_cmp_gt_u32_e64 vcc, 3, v1
    s_cbranch_vccnz L_lw_11
    ds_read2_b32 v[64:65], v27 offset1:1
    ds_read2_b32 v[66:67], v28 offset0:2 offset1:3
    ds_read2_b32 v[68:69], v37 offset0:191 offset1:192
    ds_read_b32 v70, v37 offset:1020
    ds_read_b32 v71, v37 offset:1024
    ds_read2_b32 v[40:41], v34 offset0:0 offset1:1
    ds_read2_b32 v[42:43], v34 offset0:2 offset1:3
    ds_read2_b32 v[44:45], v34 offset0:8 offset1:9
    ds_read2_b32 v[46:47], v34 offset0:10 offset1:11
    ds_read2_b32 v[48:49], v34 offset0:16 offset1:17
    ds_read2_b32 v[50:51], v34 offset0:18 offset1:19
    ds_read2_b32 v[52:53], v34 offset0:24 offset1:25
    ds_read2_b32 v[54:55], v34 offset0:26 offset1:27
    s_waitcnt lgkmcnt(10)
    s_nop 0
    v_perm_b32 v78, v66, v66, v182
    v_perm_b32 v79, v67, v66, v183
    v_perm_b32 v74, v69, v68, s84
    v_perm_b32 v75, v69, v68, s86
    v_perm_b32 v76, v64, v64, v180
    v_perm_b32 v77, v65, v64, v181
    v_mov_b32_dpp v74, v78 wave_shr:1 row_mask:0xf bank_mask:0xf
    v_mov_b32_dpp v75, v79 wave_shr:1 row_mask:0xf bank_mask:0xf
    ds_write_b128 v225, v[76:79]
    v_alignbit_b32 v80, v76, v75, 16
    v_alignbit_b32 v81, v77, v76, 16
    v_alignbit_b32 v82, v78, v77, 16
    v_alignbit_b32 v83, v79, v78, 16
    ds_write_b128 v225, v[80:83] offset:2240
    v_mov_b32 v84, v75
    v_mov_b32 v85, v76
    v_mov_b32 v86, v77
    v_mov_b32 v87, v78
    ds_write_b128 v225, v[84:87] offset:4480
    v_alignbit_b32 v88, v75, v74, 16
    v_alignbit_b32 v89, v76, v75, 16
    v_alignbit_b32 v90, v77, v76, 16
    v_alignbit_b32 v91, v78, v77, 16
    ds_write_b128 v225, v[88:91] offset:6720
    s_waitcnt lgkmcnt(12)
    v_perm_b32 v92, v71, v70, v184
    v_perm_b32 v93, v71, v70, v185
    v_perm_b32 v94, v71, v70, v186
    v_perm_b32 v95, v71, v70, v187
    ds_write_b128 v227, v[92:95]
    s_setprio 3
    s_branch L_pm_14
L_pl_12:
    s_sleep 4
    buffer_load_dword v29, v26, s[40:43], 0 offen sc1
L_pm_14:
    s_waitcnt vmcnt(0)
    v_cmp_ne_u32 vcc, s37, v29
    s_cbranch_vccz L_pd_13
    s_sub_u32 s56, s56, 1
    s_cbranch_scc0 L_pl_12
    s_mov_b32 s56, 0
L_pd_13:
    buffer_load_dwordx4 v[204:207], v224, s[40:43], s74 offen offset:0 sc1
    buffer_load_dwordx4 v[208:211], v224, s[40:43], s74 offen offset:2048 sc1
    s_setprio 1
L_uhave:
    v_and_b32 v5, 31, v0
    v_lshrrev_b32 v7, 1, v5
    v_xor_b32 v7, v7, v5
    v_and_b32 v7, 4, v7
    v_mul_u32_u24 v7, 3, v7
    v_xor_b32 v6, v7, v5
    v_lshrrev_b32 v7, 5, v0
    v_lshl_add_u32 v6, v6, 1, v7
    s_add_u32 s65, s62, 123
    v_add_u32_e64 v6, s65, v6
    s_mul_i32 s65, s63, 6208
    s_add_u32 s65, s65, 44800
    v_and_b32_e64 v9, 3, v6
    v_mul_u32_u24 v9, 1548, v9
    v_lshl_add_u32 v9, v6, 2, v9
    v_add_u32 v35, s65, v9
    v_add_u32 v6, 2, v6
    v_and_b32_e64 v9, 3, v6
    v_mul_u32_u24 v9, 1548, v9
    v_lshl_add_u32 v9, v6, 2, v9
    v_add_u32 v36, s65, v9
    v_lshlrev_b32 v7, 3, v7
    v_sub_u32 v7, v7, v5
    v_cvt_f32_i32 v7, v7
    v_add_f32 v9, -1.0, v7
    v_add_f32 v7, -2.0, v7
    v_cvt_pk_f16_f32 v8, v9, v7
    s_waitcnt vmcnt(1)
    ds_write_b128 v228, v[204:207]
    s_waitcnt vmcnt(0)
    ds_write_b128 v228, v[208:211] offset:128
    v_mov_b32 v1, 4
    ds_write_b32 v2, v1
    s_mov_b32 s65, 0x4a204a20
    s_cmp_eq_u32 s62, 0
    s_cselect_b32 s84, 0x4d104d10, s65
    s_mov_b32 s86, 0x4d804d80
    v_pk_fma_f16 v136, v8, v8, s84 neg_lo:[1,0,0] neg_hi:[1,0,0] clamp
    v_pk_add_f16 v8, v8, -2.0 op_sel_hi:[1,0]
    v_pk_fma_f16 v137, v8, v8, s84 neg_lo:[1,0,0] neg_hi:[1,0,0] clamp
    v_pk_add_f16 v8, v8, -2.0 op_sel_hi:[1,0]
    v_pk_fma_f16 v138, v8, v8, s84 neg_lo:[1,0,0] neg_hi:[1,0,0] clamp
    v_pk_add_f16 v8, v8, -2.0 op_sel_hi:[1,0]
    v_pk_fma_f16 v139, v8, v8, s84 neg_lo:[1,0,0] neg_hi:[1,0,0] clamp
    v_pk_add_f16 v8, v8, s86
    v_pk_fma_f16 v140, v8, v8, s84 neg_lo:[1,0,0] neg_hi:[1,0,0] clamp
    v_pk_add_f16 v8, v8, -2.0 op_sel_hi:[1,0]
    v_pk_fma_f16 v141, v8, v8, s84 neg_lo:[1,0,0] neg_hi:[1,0,0] clamp
    v_pk_add_f16 v8, v8, -2.0 op_sel_hi:[1,0]
    v_pk_fma_f16 v142, v8, v8, s84 neg_lo:[1,0,0] neg_hi:[1,0,0] clamp
    v_pk_add_f16 v8, v8, -2.0 op_sel_hi:[1,0]
    v_pk_fma_f16 v143, v8, v8, s84 neg_lo:[1,0,0] neg_hi:[1,0,0] clamp
    v_pk_add_f16 v8, v8, s86
    v_pk_fma_f16 v144, v8, v8, s84 neg_lo:[1,0,0] neg_hi:[1,0,0] clamp
    v_pk_add_f16 v8, v8, -2.0 op_sel_hi:[1,0]
    v_pk_fma_f16 v145, v8, v8, s84 neg_lo:[1,0,0] neg_hi:[1,0,0] clamp
    v_pk_add_f16 v8, v8, -2.0 op_sel_hi:[1,0]
    v_pk_fma_f16 v146, v8, v8, s84 neg_lo:[1,0,0] neg_hi:[1,0,0] clamp
    v_pk_add_f16 v8, v8, -2.0 op_sel_hi:[1,0]
    v_pk_fma_f16 v147, v8, v8, s84 neg_lo:[1,0,0] neg_hi:[1,0,0] clamp
L_lw_15:
    ds_read_b32 v1, v3
    s_waitcnt lgkmcnt(0)
    v_cmp_gt_u32 vcc, 4, v1
    s_cbranch_vccnz L_lw_15
    s_setprio 0
    ds_read_b128 v[112:115], v35 offset:0
    ds_read_b128 v[116:119], v36 offset:0
    ds_read_b128 v[120:123], v35 offset:16
    ds_read_b128 v[124:127], v35 offset:256
    ds_read_b128 v[128:131], v36 offset:256
    ds_read_b128 v[132:135], v35 offset:272
    ds_read_b64 v[64:65], v229 offset:0
    ds_read_b64 v[66:67], v229 offset:8
    ds_read_b128 v[72:75], v226 offset:1040
    ds_read_b128 v[68:71], v226 offset:528
    ds_read_b64 v[76:77], v229 offset:64
    ds_read_b64 v[78:79], v229 offset:72
    ds_read_b128 v[84:87], v226 offset:1024
    ds_read_b128 v[80:83], v226 offset:512
    s_mov_b64 s[48:49], s[22:23]
    s_mov_b32 s50, 401408
    s_mov_b32 s51, 0x20000
L_pad16:
    s_cbranch_execz L_pad_ret
    s_mov_b64 s[52:53], s[24:25]
    s_mov_b32 s54, 3670016
    s_mov_b32 s55, 0x20000
    v_lshrrev_b32 v6, 3, v0
    v_and_b32_e64 v7, 7, v0
    v_and_b32 v5, 0x70, v230
    v_mul_u32_u24 v234, 4096, v6
    v_add_u32 v234, v234, v5
    v_lshlrev_b32_e64 v9, 2, v0
    s_waitcnt lgkmcnt(8)
    v_mfma_f32_32x32x16_bf16 v[192:207], v[112:115], v[136:139], 0
    v_and_b32 v9, 64, v9
    v_xor_b32 v5, v5, v9
    v_mul_u32_u24 v238, 896, v6
    v_xor_b32 v9, v6, v7
    v_lshlrev_b32 v9, 4, v9
    v_mfma_f32_32x32x16_bf16 v[208:223], v[124:127], v[136:139], 0
    v_lshl_add_u32 v246, v238, 1, v9
    v_add_u32 v238, v5, v238
    v_add_u32 v239, 6144, v238
    v_lshrrev_b32 v5, 4, v0
    v_bfe_u32 v6, v0, 2, 2
    v_mfma_f32_32x32x16_bf16 v[192:207], v[116:119], v[140:143], v[192:207]
    v_lshl_or_b32 v9, v5, 3, v6
    v_lshlrev_b32 v9, 7, v9
    v_lshrrev_b32 v6, 1, v6
    v_lshl_add_u32 v9, v6, 6, v9
    v_and_b32 v6, 0x30, v230
    v_mfma_f32_32x32x16_bf16 v[208:223], v[128:131], v[140:143], v[208:223]
    s_movk_i32 s65, 1024
    v_add3_u32 v240, v6, v9, s65
    v_xor_b32 v241, 64, v240
    v_and_b32 v6, 15, v0
    v_lshlrev_b32_e64 v242, 4, v6
    v_mfma_f32_32x32x16_bf16 v[192:207], v[120:123], v[144:147], v[192:207]
    v_mad_u32_u24 v242, v5, s57, v242
    s_mul_i32 s75, s39, 9363
    s_lshr_b32 s75, s75, 16
    s_mul_i32 s65, s75, 7
    s_sub_u32 s77, s39, s65
    v_mfma_f32_32x32x16_bf16 v[208:223], v[132:135], v[144:147], v[208:223]
    s_lshl2_add_u32 s75, s75, s31
    s_lshl_b32 s70, s62, 9
    s_add_u32 s70, s70, s61
    s_lshl_b32 s70, s70, 7
    s_add_u32 s70, s70, 397312
L_pad17:
    s_cbranch_execz L_pad_ret
L_cv:
    s_waitcnt lgkmcnt(4)
    v_mfma_f32_32x32x16_bf16 v[176:191], v[64:67], v[72:75], 0
    ds_read_b64 v[88:89], v229 offset:128
    ds_read_b64 v[90:91], v229 offset:136
    ds_read_b128 v[96:99], v226 offset:1008
    ds_read_b128 v[92:95], v226 offset:496
    v_mfma_f32_32x32x16_bf16 v[160:175], v[64:67], v[68:71], 0
    s_lshl_b32 s65, s77, 8
    s_sub_u32 s65, s70, s65
    v_min_u32 v243, 6, v6
    v_lshl_add_u32 v243, v243, 8, s65
    s_waitcnt lgkmcnt(4)
    v_mfma_f32_32x32x16_bf16 v[176:191], v[76:79], v[84:87], v[176:191]
    ds_read_b64 v[100:101], v229 offset:192
    ds_read_b64 v[102:103], v229 offset:200
    ds_read_b128 v[108:111], v226 offset:992
    ds_read_b128 v[104:107], v226 offset:480
    v_mfma_f32_32x32x16_bf16 v[160:175], v[76:79], v[80:83], v[160:175]
    s_lshl_b32 s65, s31, 11
    s_add_u32 s65, s65, 1024
    v_xor_b32 v9, v5, v7
    v_lshl_add_u32 v9, v9, 4, s65
    s_waitcnt lgkmcnt(4)
    v_mfma_f32_32x32x16_bf16 v[176:191], v[88:91], v[96:99], v[176:191]
    ds_read_b64 v[64:65], v229 offset:256
    ds_read_b64 v[66:67], v229 offset:264
    ds_read_b128 v[72:75], v226 offset:976
    ds_read_b128 v[68:71], v226 offset:464
    v_mfma_f32_32x32x16_bf16 v[160:175], v[88:91], v[92:95], v[160:175]
    v_lshl_add_u32 v244, v6, 7, v9
    v_add_u32 v245, s65, v230
    s_mul_i32 s80, s75, 28672
    s_lshl_b32 s65, s77, 7
    s_waitcnt lgkmcnt(4)
    v_mfma_f32_32x32x16_bf16 v[176:191], v[100:103], v[108:111], v[176:191]
    ds_read_b64 v[76:77], v229 offset:320
    ds_read_b64 v[78:79], v229 offset:328
    ds_read_b128 v[84:87], v226 offset:960
    ds_read_b128 v[80:83], v226 offset:448
    v_mfma_f32_32x32x16_bf16 v[160:175], v[100:103], v[104:107], v[160:175]
    s_add_u32 s80, s80, s65
    s_add_u32 s80, s80, 896
    s_add_u32 s81, s80, 14336
    s_lshl_b32 s75, s75, 8
    s_waitcnt lgkmcnt(4)
    v_mfma_f32_32x32x16_bf16 v[176:191], v[64:67], v[72:75], v[176:191]
    ds_read_b64 v[88:89], v229 offset:384
    ds_read_b64 v[90:91], v229 offset:392
    ds_read_b128 v[96:99], v226 offset:944
    ds_read_b128 v[92:95], v226 offset:432
    v_mfma_f32_32x32x16_bf16 v[160:175], v[64:67], v[68:71], v[160:175]
    s_add_u32 s75, s75, 5242880
    s_lshl2_add_u32 s76, s33, s31
    s_lshl_b32 s76, s76, 4
    s_lshr_b32 s65, s35, 4
    s_waitcnt lgkmcnt(4)
    v_mfma_f32_32x32x16_bf16 v[176:191], v[76:79], v[84:87], v[176:191]
    ds_read_b64 v[100:101], v229 offset:448
    ds_read_b64 v[102:103], v229 offset:456
    ds_read_b128 v[108:111], v226 offset:928
    ds_read_b128 v[104:107], v226 offset:416
    v_mfma_f32_32x32x16_bf16 v[160:175], v[76:79], v[80:83], v[160:175]
    s_lshl_b32 s65, s65, 9
    s_add_u32 s65, s65, s76
    s_lshl_b32 s65, s65, 7
    s_add_u32 s65, s65, 397312
    s_waitcnt lgkmcnt(4)
    v_mfma_f32_32x32x16_bf16 v[176:191], v[88:91], v[96:99], v[176:191]
    ds_read_b64 v[64:65], v229 offset:512
    ds_read_b64 v[66:67], v229 offset:520
    ds_read_b128 v[72:75], v226 offset:912
    ds_read_b128 v[68:71], v226 offset:400
    v_mfma_f32_32x32x16_bf16 v[160:175], v[88:91], v[92:95], v[160:175]
    v_lshl_add_u32 v236, v6, 7, s65
    s_mov_b32 exec_lo, 0
    v_mov_b32 v236, v243
    s_mov_b64 exec, -1
    s_waitcnt lgkmcnt(4)
    v_mfma_f32_32x32x16_bf16 v[176:191], v[100:103], v[108:111], v[176:191]
    ds_read_b64 v[76:77], v229 offset:576
    ds_read_b64 v[78:79], v229 offset:584
    ds_read_b128 v[84:87], v226 offset:896
    ds_read_b128 v[80:83], v226 offset:384
    v_mfma_f32_32x32x16_bf16 v[160:175], v[100:103], v[104:107], v[160:175]
    v_lshrrev_b32 v6, 3, v0
    v_and_b32 v9, 3, v0
    v_lshl_or_b32 v237, v6, 2, v9
    v_xor_b32 v9, s31, v9
    s_waitcnt lgkmcnt(4)
    v_mfma_f32_32x32x16_bf16 v[176:191], v[64:67], v[72:75], v[176:191]
    ds_read_b64 v[88:89], v229 offset:640
    ds_read_b64 v[90:91], v229 offset:648
    ds_read_b128 v[96:99], v226 offset:880
    ds_read_b128 v[92:95], v226 offset:368
    v_mfma_f32_32x32x16_bf16 v[160:175], v[64:67], v[68:71], v[160:175]
    v_lshl_or_b32 v237, v237, 2, v9
    v_bfe_u32 v9, v0, 2, 1
    v_lshl_or_b32 v237, v237, 1, v9
    v_lshlrev_b32 v237, 4, v237
    s_waitcnt lgkmcnt(4)
    v_mfma_f32_32x32x16_bf16 v[176:191], v[76:79], v[84:87], v[176:191]
    ds_read_b64 v[100:101], v229 offset:704
    ds_read_b64 v[102:103], v229 offset:712
    ds_read_b128 v[108:111], v226 offset:864
    ds_read_b128 v[104:107], v226 offset:352
    v_mfma_f32_32x32x16_bf16 v[160:175], v[76:79], v[80:83], v[160:175]
    v_and_b32 v9, 4, v6
    v_add_u32 v9, v9, v6
    v_mul_u32_u24 v235, 1792, v9
    v_and_b32 v6, 3, v6
    s_waitcnt lgkmcnt(4)
    v_mfma_f32_32x32x16_bf16 v[176:191], v[88:91], v[96:99], v[176:191]
    ds_read_b64 v[64:65], v229 offset:768
    ds_read_b64 v[66:67], v229 offset:776
    ds_read_b128 v[72:75], v226 offset:848
    ds_read_b128 v[68:71], v226 offset:336
    v_mfma_f32_32x32x16_bf16 v[160:175], v[88:91], v[92:95], v[160:175]
    v_lshlrev_b32 v6, 1, v6
    v_xor_b32 v6, v6, v7
    v_lshl_add_u32 v235, v6, 4, v235
    s_lshl_b32 s65, s62, 12
    s_waitcnt lgkmcnt(4)
    v_mfma_f32_32x32x16_bf16 v[176:191], v[100:103], v[108:111], v[176:191]
    ds_read_b64 v[76:77], v229 offset:832
    ds_read_b64 v[78:79], v229 offset:840
    ds_read_b128 v[84:87], v226 offset:832
    ds_read_b128 v[80:83], v226 offset:320
    v_mfma_f32_32x32x16_bf16 v[160:175], v[100:103], v[104:107], v[160:175]
    s_add_u32 s66, s85, 15040
    s_sub_u32 s66, s66, s65
    v_add_u32 v232, s66, v230
    s_add_u32 s65, s65, s85
    s_waitcnt lgkmcnt(4)
    v_mfma_f32_32x32x16_bf16 v[176:191], v[64:67], v[72:75], v[176:191]
    ds_read_b64 v[88:89], v229 offset:896
    ds_read_b64 v[90:91], v229 offset:904
    ds_read_b128 v[96:99], v226 offset:816
    ds_read_b128 v[92:95], v226 offset:304
    v_mfma_f32_32x32x16_bf16 v[160:175], v[64:67], v[68:71], v[160:175]
    s_add_u32 s65, s65, 10944
    v_add_u32 v231, s65, v230
    v_lshl_add_u32 v21, v5, 4, s65
    v_bfe_u32 v5, v0, 2, 2
    s_waitcnt lgkmcnt(4)
    v_mfma_f32_32x32x16_bf16 v[176:191], v[76:79], v[84:87], v[176:191]
    ds_read_b64 v[100:101], v229 offset:960
    ds_read_b64 v[102:103], v229 offset:968
    ds_read_b128 v[108:111], v226 offset:800
    ds_read_b128 v[104:107], v226 offset:288
    v_mfma_f32_32x32x16_bf16 v[160:175], v[76:79], v[80:83], v[160:175]
    v_and_b32_e64 v9, 1, v0
    v_lshl_or_b32 v7, v9, 3, v5
    v_lshl_add_u32 v233, v7, 7, v21
    v_and_b32 v7, 2, v0
    s_waitcnt lgkmcnt(4)
    v_mfma_f32_32x32x16_bf16 v[176:191], v[88:91], v[96:99], v[176:191]
    ds_read_b64 v[64:65], v229 offset:1024
L_pad18:
    s_cbranch_execz L_pad_ret
    ds_read_b64 v[66:67], v229 offset:1032
    ds_read_b128 v[72:75], v226 offset:784
    ds_read_b128 v[68:71], v226 offset:272
    v_mfma_f32_32x32x16_bf16 v[160:175], v[88:91], v[92:95], v[160:175]
    v_lshl_add_u32 v233, v7, 2, v233
    v_cvt_pk_bf16_f32 v112, v192, v193
    v_cvt_pk_bf16_f32 v113, v194, v195
    v_cvt_pk_bf16_f32 v114, v196, v197
    s_waitcnt lgkmcnt(4)
    v_mfma_f32_32x32x16_bf16 v[176:191], v[100:103], v[108:111], v[176:191]
    ds_read_b64 v[76:77], v229 offset:1088
    ds_read_b64 v[78:79], v229 offset:1096
    ds_read_b128 v[84:87], v226 offset:768
    ds_read_b128 v[80:83], v226 offset:256
    v_mfma_f32_32x32x16_bf16 v[160:175], v[100:103], v[104:107], v[160:175]
    v_cvt_pk_bf16_f32 v115, v198, v199
    v_cvt_pk_bf16_f32 v116, v200, v201
    v_cvt_pk_bf16_f32 v117, v202, v203
    v_cvt_pk_bf16_f32 v118, v204, v205
    s_waitcnt lgkmcnt(4)
    v_mfma_f32_32x32x16_bf16 v[176:191], v[64:67], v[72:75], v[176:191]
    ds_read_b64 v[88:89], v229 offset:1152
    ds_read_b64 v[90:91], v229 offset:1160
    ds_read_b128 v[96:99], v226 offset:752
    ds_read_b128 v[92:95], v226 offset:240
    v_mfma_f32_32x32x16_bf16 v[160:175], v[64:67], v[68:71], v[160:175]
    v_cvt_pk_bf16_f32 v119, v206, v207
    v_cvt_pk_bf16_f32 v120, v208, v209
    v_cvt_pk_bf16_f32 v121, v210, v211
    v_cvt_pk_bf16_f32 v122, v212, v213
    s_waitcnt lgkmcnt(4)
    v_mfma_f32_32x32x16_bf16 v[176:191], v[76:79], v[84:87], v[176:191]
    ds_read_b64 v[100:101], v229 offset:1216
    ds_read_b64 v[102:103], v229 offset:1224
    ds_read_b128 v[108:111], v226 offset:736
    ds_read_b128 v[104:107], v226 offset:224
    v_mfma_f32_32x32x16_bf16 v[160:175], v[76:79], v[80:83], v[160:175]
    v_cvt_pk_bf16_f32 v123, v214, v215
    v_cvt_pk_bf16_f32 v124, v216, v217
    v_cvt_pk_bf16_f32 v125, v218, v219
    v_cvt_pk_bf16_f32 v126, v220, v221
    s_waitcnt lgkmcnt(4)
    v_mfma_f32_32x32x16_bf16 v[176:191], v[88:91], v[96:99], v[176:191]
    ds_read_b64 v[64:65], v229 offset:1280
    ds_read_b64 v[66:67], v229 offset:1288
    ds_read_b128 v[72:75], v226 offset:720
    ds_read_b128 v[68:71], v226 offset:208
    v_mfma_f32_32x32x16_bf16 v[160:175], v[88:91], v[92:95], v[160:175]
    v_cvt_pk_bf16_f32 v127, v222, v223
    s_waitcnt lgkmcnt(4)
    v_mfma_f32_32x32x16_bf16 v[176:191], v[100:103], v[108:111], v[176:191]
    ds_read_b64 v[76:77], v229 offset:1344
    ds_read_b64 v[78:79], v229 offset:1352
    ds_read_b128 v[84:87], v226 offset:704
    ds_read_b128 v[80:83], v226 offset:192
    v_mfma_f32_32x32x16_bf16 v[160:175], v[100:103], v[104:107], v[160:175]
    s_waitcnt lgkmcnt(4)
    v_mfma_f32_32x32x16_bf16 v[176:191], v[64:67], v[72:75], v[176:191]
    ds_read_b64 v[88:89], v229 offset:1408
    ds_read_b64 v[90:91], v229 offset:1416
    ds_read_b128 v[96:99], v226 offset:688
    ds_read_b128 v[92:95], v226 offset:176
    v_mfma_f32_32x32x16_bf16 v[160:175], v[64:67], v[68:71], v[160:175]
    s_waitcnt lgkmcnt(4)
    v_mfma_f32_32x32x16_bf16 v[176:191], v[76:79], v[84:87], v[176:191]
    ds_read_b64 v[100:101], v229 offset:1472
    ds_read_b64 v[102:103], v229 offset:1480
    ds_read_b128 v[108:111], v226 offset:672
    ds_read_b128 v[104:107], v226 offset:160
    v_mfma_f32_32x32x16_bf16 v[160:175], v[76:79], v[80:83], v[160:175]
    s_waitcnt lgkmcnt(4)
    v_mfma_f32_32x32x16_bf16 v[176:191], v[88:91], v[96:99], v[176:191]
    ds_read_b64 v[64:65], v229 offset:1536
    ds_read_b64 v[66:67], v229 offset:1544
    ds_read_b128 v[72:75], v226 offset:656
    ds_read_b128 v[68:71], v226 offset:144
    v_mfma_f32_32x32x16_bf16 v[160:175], v[88:91], v[92:95], v[160:175]
    s_waitcnt lgkmcnt(4)
    v_mfma_f32_32x32x16_bf16 v[176:191], v[100:103], v[108:111], v[176:191]
    ds_read_b64 v[76:77], v229 offset:1600
    ds_read_b64 v[78:79], v229 offset:1608
    ds_read_b128 v[84:87], v226 offset:640
    ds_read_b128 v[80:83], v226 offset:128
    v_mfma_f32_32x32x16_bf16 v[160:175], v[100:103], v[104:107], v[160:175]
    s_waitcnt lgkmcnt(4)
    v_mfma_f32_32x32x16_bf16 v[176:191], v[64:67], v[72:75], v[176:191]
    ds_read_b64 v[88:89], v229 offset:1664
    ds_read_b64 v[90:91], v229 offset:1672
    ds_read_b128 v[96:99], v226 offset:624
    ds_read_b128 v[92:95], v226 offset:112
    v_mfma_f32_32x32x16_bf16 v[160:175], v[64:67], v[68:71], v[160:175]
    s_waitcnt lgkmcnt(4)
    v_mfma_f32_32x32x16_bf16 v[176:191], v[76:79], v[84:87], v[176:191]
    ds_read_b64 v[100:101], v229 offset:1728
    ds_read_b64 v[102:103], v229 offset:1736
    ds_read_b128 v[108:111], v226 offset:608
    ds_read_b128 v[104:107], v226 offset:96
    v_mfma_f32_32x32x16_bf16 v[160:175], v[76:79], v[80:83], v[160:175]
    s_waitcnt lgkmcnt(4)
    v_mfma_f32_32x32x16_bf16 v[176:191], v[88:91], v[96:99], v[176:191]
    ds_read_b64 v[64:65], v229 offset:1792
    ds_read_b64 v[66:67], v229 offset:1800
    ds_read_b128 v[72:75], v226 offset:592
    ds_read_b128 v[68:71], v226 offset:80
    v_mfma_f32_32x32x16_bf16 v[160:175], v[88:91], v[92:95], v[160:175]
    s_waitcnt lgkmcnt(4)
    v_mfma_f32_32x32x16_bf16 v[176:191], v[100:103], v[108:111], v[176:191]
    ds_read_b64 v[76:77], v229 offset:1856
    ds_read_b64 v[78:79], v229 offset:1864
    ds_read_b128 v[84:87], v226 offset:576
    ds_read_b128 v[80:83], v226 offset:64
    v_mfma_f32_32x32x16_bf16 v[160:175], v[100:103], v[104:107], v[160:175]
    s_waitcnt lgkmcnt(4)
    v_mfma_f32_32x32x16_bf16 v[176:191], v[64:67], v[72:75], v[176:191]
    ds_read_b64 v[88:89], v229 offset:1920
    ds_read_b64 v[90:91], v229 offset:1928
    ds_read_b128 v[96:99], v226 offset:560
    ds_read_b128 v[92:95], v226 offset:48
    v_mfma_f32_32x32x16_bf16 v[160:175], v[64:67], v[68:71], v[160:175]
    s_waitcnt lgkmcnt(4)
    v_mfma_f32_32x32x16_bf16 v[176:191], v[76:79], v[84:87], v[176:191]
    ds_read_b64 v[100:101], v229 offset:1984
    ds_read_b64 v[102:103], v229 offset:1992
    ds_read_b128 v[108:111], v226 offset:544
    ds_read_b128 v[104:107], v226 offset:32
    v_mfma_f32_32x32x16_bf16 v[160:175], v[76:79], v[80:83], v[160:175]
    s_waitcnt lgkmcnt(4)
    v_mfma_f32_32x32x16_bf16 v[176:191], v[88:91], v[96:99], v[176:191]
    ds_read_b64 v[64:65], v229 offset:2048
    ds_read_b64 v[66:67], v229 offset:2056
    ds_read_b128 v[72:75], v226 offset:528
    v_mfma_f32_32x32x16_bf16 v[160:175], v[88:91], v[92:95], v[160:175]
    s_waitcnt lgkmcnt(3)
    v_mfma_f32_32x32x16_bf16 v[176:191], v[100:103], v[108:111], v[176:191]
    ds_read_b64 v[76:77], v229 offset:2112
    ds_read_b64 v[78:79], v229 offset:2120
    ds_read_b128 v[84:87], v226 offset:512
L_pad19:
    s_cbranch_execz L_pad_ret
    v_mfma_f32_32x32x16_bf16 v[160:175], v[100:103], v[104:107], v[160:175]
    s_waitcnt lgkmcnt(3)
    v_mfma_f32_32x32x16_bf16 v[176:191], v[64:67], v[72:75], v[176:191]
    s_waitcnt lgkmcnt(0)
    v_mfma_f32_32x32x16_bf16 v[176:191], v[76:79], v[84:87], v[176:191]
    v_mfma_f32_32x32x16_bf16 v[176:191], v[112:115], v[40:43], v[176:191]
    v_mfma_f32_32x32x16_bf16 v[176:191], v[116:119], v[44:47], v[176:191]
    v_mfma_f32_32x32x16_bf16 v[176:191], v[120:123], v[48:51], v[176:191]
    v_mfma_f32_32x32x16_bf16 v[176:191], v[124:127], v[52:55], v[176:191]
    s_setprio 2
    s_mul_i32 s65, s61, 4096
    s_lshl_b32 s66, s62, 11
    s_add_u32 s65, s65, s66
    s_add_u32 s65, s65, 9437184
    s_nop 4
    s_cmp_eq_u32 s62, 0
    s_cbranch_scc1 L_x0
    ds_write_b128 v232, v[160:163] offset:0
    ds_write_b128 v232, v[164:167] offset:1024
    ds_write_b128 v232, v[168:171] offset:2048
    ds_write_b128 v232, v[172:175] offset:3072
    v_mov_b32 v1, 6
    ds_write_b32 v2, v1
L_lw_16:
    ds_read_b32 v1, v32
    s_waitcnt lgkmcnt(0)
    v_cmp_gt_u32_e64 vcc, 6, v1
    s_cbranch_vccnz L_lw_16
    ds_read_b128 v[160:163], v231 offset:0
    ds_read_b128 v[164:167], v231 offset:1024
    ds_read_b128 v[168:171], v231 offset:2048
    ds_read_b128 v[172:175], v231 offset:3072
    s_waitcnt lgkmcnt(0)
    s_branch L_x1
L_x0:
    ds_write_b128 v232, v[176:179] offset:0
    ds_write_b128 v232, v[180:183] offset:1024
    ds_write_b128 v232, v[184:187] offset:2048
    ds_write_b128 v232, v[188:191] offset:3072
    v_mov_b32 v1, 6
    ds_write_b32 v2, v1
L_lw_17:
    ds_read_b32 v1, v32
    s_waitcnt lgkmcnt(0)
    v_cmp_gt_u32 vcc, 6, v1
    s_cbranch_vccnz L_lw_17
    ds_read_b128 v[176:179], v231 offset:0
    ds_read_b128 v[180:183], v231 offset:1024
    ds_read_b128 v[184:187], v231 offset:2048
    ds_read_b128 v[188:191], v231 offset:3072
    s_waitcnt lgkmcnt(0)
    s_nop 0
L_x1:
    v_pk_add_f32 v[160:161], v[160:161], v[176:177]
    v_pk_add_f32 v[162:163], v[162:163], v[178:179]
    v_pk_add_f32 v[164:165], v[164:165], v[180:181]
    v_pk_add_f32 v[166:167], v[166:167], v[182:183]
    v_pk_add_f32 v[168:169], v[168:169], v[184:185]
    v_pk_add_f32 v[170:171], v[170:171], v[186:187]
    v_pk_add_f32 v[172:173], v[172:173], v[188:189]
    v_pk_add_f32 v[174:175], v[174:175], v[190:191]
    v_cvt_pk_bf16_f32 v176, v160, v161
    v_cvt_pk_bf16_f32 v177, v162, v163
    v_cvt_pk_bf16_f32 v178, v164, v165
    v_cvt_pk_bf16_f32 v179, v166, v167
    v_cvt_pk_bf16_f32 v180, v168, v169
    v_cvt_pk_bf16_f32 v181, v170, v171
    v_cvt_pk_bf16_f32 v182, v172, v173
    v_cvt_pk_bf16_f32 v183, v174, v175
    buffer_store_dwordx4 v[176:179], v230, s[40:43], s65 offen sc1
    buffer_store_dwordx4 v[180:183], v230, s[40:43], s65 offen offset:1024 sc1
    v_subrev_u32 v5, 16, v3
    v_mov_b64 v[160:161], -1
    v_mov_b64 v[162:163], -1
    s_mul_i32 s65, s77, 262144
    s_add_u32 s65, s65, s75
    s_add_u32 s68, s65, 131072
    buffer_store_dwordx4 v[160:163], v242, s[40:43], s65 offen sc1
    buffer_store_dwordx4 v[160:163], v242, s[40:43], s68 offen sc1
    v_mov_b32 v1, 7
    ds_write_b32 v2, v1
L_lw_18:
    ds_read_b32 v1, v3
    s_waitcnt lgkmcnt(0)
    v_cmp_gt_u32 vcc, 7, v1
    s_cbranch_vccnz L_lw_18
L_lw_19:
    ds_read_b32 v1, v5
    s_waitcnt lgkmcnt(0)
    v_cmp_gt_u32 vcc, 8, v1
    s_cbranch_vccnz L_lw_19
    s_waitcnt vmcnt(0)
    v_mov_b32 v1, s37
    v_mov_b32 v5, 0
    s_mov_b64 exec, 1
    buffer_store_dword v1, v5, s[40:43], s70 offen sc1
    s_mov_b64 exec, -1
    s_mul_i32 s65, s31, 14336
    s_lshl_b32 s66, s77, 7
    s_add_u32 s65, s65, s66
    s_lshl_b32 s66, s31, 11
    s_add_u32 s66, s66, 1024
    s_add_u32 m0, s66, 0
    s_add_u32 s68, s65, 0
    buffer_load_dwordx4 v238, s[48:51], s68 offen lds
    buffer_load_dwordx4 v239, s[48:51], s68 offen offset:1024 lds
    s_waitcnt vmcnt(2)
    s_add_u32 m0, s66, 8192
    s_add_u32 s68, s65, 57344
    buffer_load_dwordx4 v238, s[48:51], s68 offen lds
    buffer_load_dwordx4 v239, s[48:51], s68 offen offset:1024 lds
    s_waitcnt vmcnt(2)
    s_add_u32 m0, s66, 16384
    s_add_u32 s68, s65, 114688
    buffer_load_dwordx4 v238, s[48:51], s68 offen lds
    buffer_load_dwordx4 v239, s[48:51], s68 offen offset:1024 lds
    s_waitcnt vmcnt(2)
    s_add_u32 m0, s66, 24576
    s_add_u32 s68, s65, 172032
    buffer_load_dwordx4 v238, s[48:51], s68 offen lds
    buffer_load_dwordx4 v239, s[48:51], s68 offen offset:1024 lds
    s_waitcnt vmcnt(2)
    s_add_u32 m0, s66, 32768
    s_add_u32 s68, s65, 229376
    buffer_load_dwordx4 v238, s[48:51], s68 offen lds
    buffer_load_dwordx4 v239, s[48:51], s68 offen offset:1024 lds
    s_waitcnt vmcnt(2)
    s_add_u32 m0, s66, 40960
    s_add_u32 s68, s65, 286720
    buffer_load_dwordx4 v238, s[48:51], s68 offen lds
    buffer_load_dwordx4 v239, s[48:51], s68 offen offset:1024 lds
    s_waitcnt vmcnt(2)
    s_add_u32 m0, s66, 49152
    s_add_u32 s68, s65, 344064
    buffer_load_dwordx4 v238, s[48:51], s68 offen lds
    buffer_load_dwordx4 v239, s[48:51], s68 offen offset:1024 lds
    s_waitcnt vmcnt(0)
    v_mov_b32_e64 v1, 8
    ds_write_b32 v2, v1
    buffer_load_dword v5, v236, s[40:43], 0 offen sc1
    s_mul_i32 s65, s76, 4096
    s_lshl_b32 s68, s35, 7
    s_add_u32 s65, s65, s68
    s_add_u32 s65, s65, 9437184
    s_add_u32 s68, s65, 32768
L_lw_20:
    ds_read_b32 v1, v3
    s_waitcnt lgkmcnt(0)
    v_cmp_gt_u32_e64 vcc, 8, v1
    s_cbranch_vccnz L_lw_20
    ds_read_b64_tr_b16 v[8:9], v240 offset:0
    ds_read_b64_tr_b16 v[10:11], v240 offset:512
    ds_read_b64_tr_b16 v[12:13], v240 offset:8
    ds_read_b64_tr_b16 v[14:15], v240 offset:520
    ds_read_b64_tr_b16 v[16:17], v241 offset:0
    ds_read_b64_tr_b16 v[18:19], v241 offset:512
    ds_read_b64_tr_b16 v[20:21], v241 offset:8
    ds_read_b64_tr_b16 v[22:23], v241 offset:520
    ds_read_b64_tr_b16 v[24:25], v240 offset:4096
    ds_read_b64_tr_b16 v[26:27], v240 offset:4608
    ds_read_b64_tr_b16 v[28:29], v240 offset:4104
    ds_read_b64_tr_b16 v[30:31], v240 offset:4616
    ds_read_b64_tr_b16 v[32:33], v241 offset:4096
    ds_read_b64_tr_b16 v[34:35], v241 offset:4608
    ds_read_b64_tr_b16 v[36:37], v241 offset:4104
    ds_read_b64_tr_b16 v[38:39], v241 offset:4616
    ds_read_b64_tr_b16 v[40:41], v240 offset:8192
    ds_read_b64_tr_b16 v[42:43], v240 offset:8704
    ds_read_b64_tr_b16 v[44:45], v240 offset:8200
    ds_read_b64_tr_b16 v[46:47], v240 offset:8712
    ds_read_b64_tr_b16 v[48:49], v241 offset:8192
    ds_read_b64_tr_b16 v[50:51], v241 offset:8704
    ds_read_b64_tr_b16 v[52:53], v241 offset:8200
L_pad20:
    s_cbranch_execz L_pad_ret
    s_nop 0
    ds_read_b64_tr_b16 v[54:55], v241 offset:8712
    ds_read_b64_tr_b16 v[56:57], v240 offset:12288
    ds_read_b64_tr_b16 v[58:59], v240 offset:12800
    ds_read_b64_tr_b16 v[60:61], v240 offset:12296
    ds_read_b64_tr_b16 v[62:63], v240 offset:12808
    ds_read_b64_tr_b16 v[64:65], v241 offset:12288
    ds_read_b64_tr_b16 v[66:67], v241 offset:12800
    ds_read_b64_tr_b16 v[68:69], v241 offset:12296
    ds_read_b64_tr_b16 v[70:71], v241 offset:12808
    ds_read_b64_tr_b16 v[72:73], v240 offset:16384
    ds_read_b64_tr_b16 v[74:75], v240 offset:16896
    ds_read_b64_tr_b16 v[76:77], v240 offset:16392
    ds_read_b64_tr_b16 v[78:79], v240 offset:16904
    ds_read_b64_tr_b16 v[80:81], v241 offset:16384
    ds_read_b64_tr_b16 v[82:83], v241 offset:16896
    ds_read_b64_tr_b16 v[84:85], v241 offset:16392
    ds_read_b64_tr_b16 v[86:87], v241 offset:16904
    ds_read_b64_tr_b16 v[88:89], v240 offset:20480
    ds_read_b64_tr_b16 v[90:91], v240 offset:20992
    ds_read_b64_tr_b16 v[92:93], v240 offset:20488
    ds_read_b64_tr_b16 v[94:95], v240 offset:21000
    ds_read_b64_tr_b16 v[96:97], v241 offset:20480
    ds_read_b64_tr_b16 v[98:99], v241 offset:20992
    ds_read_b64_tr_b16 v[100:101], v241 offset:20488
    ds_read_b64_tr_b16 v[102:103], v241 offset:21000
    ds_read_b64_tr_b16 v[104:105], v240 offset:24576
    ds_read_b64_tr_b16 v[106:107], v240 offset:25088
    ds_read_b64_tr_b16 v[108:109], v240 offset:24584
    ds_read_b64_tr_b16 v[110:111], v240 offset:25096
    ds_read_b64_tr_b16 v[112:113], v241 offset:24576
    ds_read_b64_tr_b16 v[114:115], v241 offset:25088
    ds_read_b64_tr_b16 v[116:117], v241 offset:24584
    ds_read_b64_tr_b16 v[118:119], v241 offset:25096
    ds_read_b64_tr_b16 v[120:121], v240 offset:28672
    ds_read_b64_tr_b16 v[122:123], v240 offset:29184
    ds_read_b64_tr_b16 v[124:125], v240 offset:28680
    ds_read_b64_tr_b16 v[126:127], v240 offset:29192
    ds_read_b64_tr_b16 v[128:129], v241 offset:28672
    ds_read_b64_tr_b16 v[130:131], v241 offset:29184
    ds_read_b64_tr_b16 v[132:133], v241 offset:28680
    ds_read_b64_tr_b16 v[134:135], v241 offset:29192
    ds_read_b64_tr_b16 v[136:137], v240 offset:32768
    ds_read_b64_tr_b16 v[138:139], v240 offset:33280
    ds_read_b64_tr_b16 v[140:141], v240 offset:32776
    ds_read_b64_tr_b16 v[142:143], v240 offset:33288
    ds_read_b64_tr_b16 v[144:145], v241 offset:32768
    ds_read_b64_tr_b16 v[146:147], v241 offset:33280
    ds_read_b64_tr_b16 v[148:149], v241 offset:32776
    ds_read_b64_tr_b16 v[150:151], v241 offset:33288
    ds_read_b64_tr_b16 v[152:153], v240 offset:36864
    ds_read_b64_tr_b16 v[154:155], v240 offset:37376
    ds_read_b64_tr_b16 v[156:157], v240 offset:36872
    ds_read_b64_tr_b16 v[158:159], v240 offset:37384
    ds_read_b64_tr_b16 v[160:161], v241 offset:36864
    ds_read_b64_tr_b16 v[162:163], v241 offset:37376
    ds_read_b64_tr_b16 v[164:165], v241 offset:36872
    ds_read_b64_tr_b16 v[166:167], v241 offset:37384
    v_mov_b32 v1, 9
    ds_write_b32 v2, v1
    s_branch L_pm_23
L_pl_21:
    s_sleep 8
    buffer_load_dword v5, v236, s[40:43], 0 offen sc1
L_pm_23:
    s_waitcnt vmcnt(0)
    v_cmp_ne_u32_e64 vcc, s37, v5
    s_cbranch_vccz L_pd_22
    s_sub_u32 s56, s56, 1
    s_cbranch_scc0 L_pl_21
    s_mov_b32 s56, 0
L_pd_22:
    buffer_load_dwordx4 v[168:171], v234, s[40:43], s65 offen sc1
    buffer_load_dwordx4 v[172:175], v234, s[40:43], s68 offen sc1
    s_lshr_b32 s65, s35, 4
    s_lshl_b32 s65, s65, 10
    s_and_b32 s66, s35, 3
    s_lshl_b32 s66, s66, 8
    s_add_u32 s65, s65, s66
    s_and_b32 s66, s35, 8
    s_lshl1_add_u32 s65, s66, s65
    s_and_b32 s66, s35, 4
    s_add_u32 s65, s65, s66
    s_lshl_b32 s66, s31, 6
    s_add_u32 s65, s65, s66
    s_mul_i32 s65, s65, 1792
    s_lshl_b32 s66, s33, 7
    s_add_u32 s65, s65, s66
    s_add_u32 s66, s65, 57344
    v_xor_b32 v5, 64, v244
L_lw_24:
    ds_read_b32 v1, v3
    s_waitcnt lgkmcnt(0)
    v_cmp_gt_u32 vcc, 9, v1
    s_cbranch_vccnz L_lw_24
    s_waitcnt vmcnt(0)
    ds_write_b128 v231, v[168:171]
    ds_write_b128 v231, v[172:175] offset:1024
    ds_read_b64_tr_b16 v[176:177], v233 offset:0
    ds_read_b64_tr_b16 v[178:179], v233 offset:512
    ds_read_b64_tr_b16 v[180:181], v233 offset:64
    ds_read_b64_tr_b16 v[182:183], v233 offset:576
    s_waitcnt lgkmcnt(0)
    ds_write_b128 v237, v[176:179] offset:1024
    ds_write_b128 v237, v[180:183] offset:5120
    v_mov_b32 v1, 10
    ds_write_b32 v2, v1
L_lw_25:
    ds_read_b32 v1, v3
    s_waitcnt lgkmcnt(0)
    v_cmp_gt_u32 vcc, 10, v1
    s_cbranch_vccnz L_lw_25
    ds_read_b128 v[176:179], v245
    ds_read_b128 v[180:183], v245 offset:1024
    s_waitcnt lgkmcnt(0)
    buffer_store_dwordx4 v[176:179], v235, s[52:55], s65 offen sc1
    buffer_store_dwordx4 v[180:183], v235, s[52:55], s66 offen sc1
    s_add_u32 s4, s75, 0
    s_nop 0
    s_add_u32 s5, s75, 131072
    s_add_u32 s6, s75, 262144
    s_add_u32 s7, s75, 393216
    s_add_u32 s8, s75, 524288
    s_add_u32 s9, s75, 655360
    s_add_u32 s10, s75, 786432
    s_add_u32 s11, s75, 917504
    s_add_u32 s12, s75, 1048576
    s_add_u32 s13, s75, 1179648
    s_add_u32 s14, s75, 1310720
    s_add_u32 s15, s75, 1441792
    s_add_u32 s16, s75, 1572864
    s_add_u32 s17, s75, 1703936
    s_mov_b64 exec, 0
    s_branch L_qad0
L_qad_ret:
    s_mov_b64 exec, -1
    s_min_u32 s56, s56, 0x4000
L_obar:
    s_barrier
    buffer_load_dwordx4 v[168:171], v242, s[40:43], s4 offen sc1
    buffer_load_dwordx4 v[172:175], v242, s[40:43], s5 offen sc1
    buffer_load_dwordx4 v[176:179], v242, s[40:43], s6 offen sc1
    buffer_load_dwordx4 v[180:183], v242, s[40:43], s7 offen sc1
    buffer_load_dwordx4 v[184:187], v242, s[40:43], s8 offen sc1
    buffer_load_dwordx4 v[188:191], v242, s[40:43], s9 offen sc1
    buffer_load_dwordx4 v[192:195], v242, s[40:43], s10 offen sc1
    buffer_load_dwordx4 v[196:199], v242, s[40:43], s11 offen sc1
    s_waitcnt vmcnt(7)
    v_max3_u32 v6, v168, v169, v170
    v_max_u32 v6, v6, v171
    v_cmp_eq_u32 vcc, -1, v6
    s_cbranch_vccnz L_or0
L_og0:
    buffer_load_dwordx4 v[200:203], v242, s[40:43], s12 offen sc1
    v_mfma_f32_16x16x32_bf16 v[224:227], v[8:11], v[168:171], 0
    v_mfma_f32_16x16x32_bf16 v[228:231], v[12:15], v[168:171], 0
    s_waitcnt vmcnt(7)
    v_max3_u32 v6, v172, v173, v174
    v_mfma_f32_16x16x32_bf16 v[232:235], v[16:19], v[168:171], 0
    v_max_u32 v6, v6, v175
    v_cmp_eq_u32 vcc, -1, v6
    v_mfma_f32_16x16x32_bf16 v[236:239], v[20:23], v[168:171], 0
    s_cbranch_vccnz L_or1
L_og1:
    buffer_load_dwordx4 v[204:207], v242, s[40:43], s13 offen sc1
    v_mfma_f32_16x16x32_bf16 v[224:227], v[24:27], v[172:175], v[224:227]
    ds_read_b64_tr_b16 v[8:9], v240 offset:40960
    ds_read_b64_tr_b16 v[10:11], v240 offset:41472
    v_mfma_f32_16x16x32_bf16 v[228:231], v[28:31], v[172:175], v[228:231]
    ds_read_b64_tr_b16 v[12:13], v240 offset:40968
    ds_read_b64_tr_b16 v[14:15], v240 offset:41480
    s_waitcnt vmcnt(7)
    v_max3_u32 v6, v176, v177, v178
    v_mfma_f32_16x16x32_bf16 v[232:235], v[32:35], v[172:175], v[232:235]
    v_max_u32 v6, v6, v179
    v_cmp_eq_u32 vcc, -1, v6
    v_mfma_f32_16x16x32_bf16 v[236:239], v[36:39], v[172:175], v[236:239]
    s_cbranch_vccnz L_or2
L_og2:
    buffer_load_dwordx4 v[208:211], v242, s[40:43], s14 offen sc1
    v_mfma_f32_16x16x32_bf16 v[224:227], v[40:43], v[176:179], v[224:227]
    ds_read_b64_tr_b16 v[16:17], v241 offset:40960
    ds_read_b64_tr_b16 v[18:19], v241 offset:41472
    v_mfma_f32_16x16x32_bf16 v[228:231], v[44:47], v[176:179], v[228:231]
    ds_read_b64_tr_b16 v[20:21], v241 offset:40968
    ds_read_b64_tr_b16 v[22:23], v241 offset:41480
    s_waitcnt vmcnt(7)
    v_max3_u32 v6, v180, v181, v182
    v_mfma_f32_16x16x32_bf16 v[232:235], v[48:51], v[176:179], v[232:235]
    v_max_u32 v6, v6, v183
    v_cmp_eq_u32 vcc, -1, v6
    v_mfma_f32_16x16x32_bf16 v[236:239], v[52:55], v[176:179], v[236:239]
    s_cbranch_vccnz L_or3
L_og3:
    buffer_load_dwordx4 v[212:215], v242, s[40:43], s15 offen sc1
    v_mfma_f32_16x16x32_bf16 v[224:227], v[56:59], v[180:183], v[224:227]
    ds_read_b64_tr_b16 v[24:25], v240 offset:45056
    ds_read_b64_tr_b16 v[26:27], v240 offset:45568
    v_mfma_f32_16x16x32_bf16 v[228:231], v[60:63], v[180:183], v[228:231]
    ds_read_b64_tr_b16 v[28:29], v240 offset:45064
    ds_read_b64_tr_b16 v[30:31], v240 offset:45576
    s_waitcnt vmcnt(7)
    v_max3_u32 v6, v184, v185, v186
    v_mfma_f32_16x16x32_bf16 v[232:235], v[64:67], v[180:183], v[232:235]
    v_max_u32 v6, v6, v187
    v_cmp_eq_u32 vcc, -1, v6
    v_mfma_f32_16x16x32_bf16 v[236:239], v[68:71], v[180:183], v[236:239]
    s_cbranch_vccnz L_or4
L_og4:
    buffer_load_dwordx4 v[216:219], v242, s[40:43], s16 offen sc1
    v_mfma_f32_16x16x32_bf16 v[224:227], v[72:75], v[184:187], v[224:227]
    ds_read_b64_tr_b16 v[32:33], v241 offset:45056
    ds_read_b64_tr_b16 v[34:35], v241 offset:45568
    v_mfma_f32_16x16x32_bf16 v[228:231], v[76:79], v[184:187], v[228:231]
    ds_read_b64_tr_b16 v[36:37], v241 offset:45064
    ds_read_b64_tr_b16 v[38:39], v241 offset:45576
    s_waitcnt vmcnt(7)
    v_max3_u32 v6, v188, v189, v190
L_qad0:
    s_cbranch_execz L_qad1
    v_mfma_f32_16x16x32_bf16 v[232:235], v[80:83], v[184:187], v[232:235]
    v_max_u32 v6, v6, v191
    v_cmp_eq_u32 vcc, -1, v6
    v_mfma_f32_16x16x32_bf16 v[236:239], v[84:87], v[184:187], v[236:239]
    s_cbranch_vccnz L_or5
L_og5:
    buffer_load_dwordx4 v[220:223], v242, s[40:43], s17 offen sc1
    v_mfma_f32_16x16x32_bf16 v[224:227], v[88:91], v[188:191], v[224:227]
    ds_read_b64_tr_b16 v[40:41], v240 offset:49152
    ds_read_b64_tr_b16 v[42:43], v240 offset:49664
    v_mfma_f32_16x16x32_bf16 v[228:231], v[92:95], v[188:191], v[228:231]
    ds_read_b64_tr_b16 v[44:45], v240 offset:49160
    ds_read_b64_tr_b16 v[46:47], v240 offset:49672
    s_waitcnt vmcnt(7)
    v_max3_u32 v6, v192, v193, v194
    v_mfma_f32_16x16x32_bf16 v[232:235], v[96:99], v[188:191], v[232:235]
    v_max_u32 v6, v6, v195
    v_cmp_eq_u32 vcc, -1, v6
    v_mfma_f32_16x16x32_bf16 v[236:239], v[100:103], v[188:191], v[236:239]
    s_cbranch_vccnz L_or6
L_og6:
    v_mfma_f32_16x16x32_bf16 v[224:227], v[104:107], v[192:195], v[224:227]
    ds_read_b64_tr_b16 v[48:49], v241 offset:49152
    ds_read_b64_tr_b16 v[50:51], v241 offset:49664
    v_mfma_f32_16x16x32_bf16 v[228:231], v[108:111], v[192:195], v[228:231]
    ds_read_b64_tr_b16 v[52:53], v241 offset:49160
    ds_read_b64_tr_b16 v[54:55], v241 offset:49672
    s_waitcnt vmcnt(6)
    v_max3_u32 v6, v196, v197, v198
    v_mfma_f32_16x16x32_bf16 v[232:235], v[112:115], v[192:195], v[232:235]
    v_max_u32 v6, v6, v199
    v_cmp_eq_u32 vcc, -1, v6
    v_mfma_f32_16x16x32_bf16 v[236:239], v[116:119], v[192:195], v[236:239]
    s_cbranch_vccnz L_or7
L_og7:
    v_mfma_f32_16x16x32_bf16 v[224:227], v[120:123], v[196:199], v[224:227]
    ds_read_b64_tr_b16 v[56:57], v240 offset:53248
    ds_read_b64_tr_b16 v[58:59], v240 offset:53760
    v_mfma_f32_16x16x32_bf16 v[228:231], v[124:127], v[196:199], v[228:231]
    ds_read_b64_tr_b16 v[60:61], v240 offset:53256
    ds_read_b64_tr_b16 v[62:63], v240 offset:53768
    s_waitcnt vmcnt(5)
    v_max3_u32 v6, v200, v201, v202
    v_mfma_f32_16x16x32_bf16 v[232:235], v[128:131], v[196:199], v[232:235]
    v_max_u32 v6, v6, v203
    v_cmp_eq_u32 vcc, -1, v6
    v_mfma_f32_16x16x32_bf16 v[236:239], v[132:135], v[196:199], v[236:239]
    s_cbranch_vccnz L_or8
L_og8:
    v_mfma_f32_16x16x32_bf16 v[224:227], v[136:139], v[200:203], v[224:227]
    ds_read_b64_tr_b16 v[64:65], v241 offset:53248
    ds_read_b64_tr_b16 v[66:67], v241 offset:53760
    v_mfma_f32_16x16x32_bf16 v[228:231], v[140:143], v[200:203], v[228:231]
    ds_read_b64_tr_b16 v[68:69], v241 offset:53256
    ds_read_b64_tr_b16 v[70:71], v241 offset:53768
    s_waitcnt vmcnt(4)
    v_max3_u32 v6, v204, v205, v206
    v_mfma_f32_16x16x32_bf16 v[232:235], v[144:147], v[200:203], v[232:235]
    v_max_u32 v6, v6, v207
    v_cmp_eq_u32 vcc, -1, v6
    v_mfma_f32_16x16x32_bf16 v[236:239], v[148:151], v[200:203], v[236:239]
    s_cbranch_vccnz L_or9
L_og9:
    v_mfma_f32_16x16x32_bf16 v[224:227], v[152:155], v[204:207], v[224:227]
    v_mfma_f32_16x16x32_bf16 v[228:231], v[156:159], v[204:207], v[228:231]
    s_waitcnt vmcnt(3)
    v_max3_u32 v6, v208, v209, v210
    v_mfma_f32_16x16x32_bf16 v[232:235], v[160:163], v[204:207], v[232:235]
    v_max_u32 v6, v6, v211
    v_cmp_eq_u32 vcc, -1, v6
    v_mfma_f32_16x16x32_bf16 v[236:239], v[164:167], v[204:207], v[236:239]
    s_waitcnt lgkmcnt(0)
    s_cbranch_vccnz L_or10
L_og10:
    v_mfma_f32_16x16x32_bf16 v[224:227], v[8:11], v[208:211], v[224:227]
    v_mfma_f32_16x16x32_bf16 v[228:231], v[12:15], v[208:211], v[228:231]
    s_waitcnt vmcnt(2)
    v_max3_u32 v6, v212, v213, v214
    v_mfma_f32_16x16x32_bf16 v[232:235], v[16:19], v[208:211], v[232:235]
    v_max_u32 v6, v6, v215
    v_cmp_eq_u32 vcc, -1, v6
    v_mfma_f32_16x16x32_bf16 v[236:239], v[20:23], v[208:211], v[236:239]
    s_cbranch_vccnz L_or11
L_og11:
    v_mfma_f32_16x16x32_bf16 v[224:227], v[24:27], v[212:215], v[224:227]
    v_mfma_f32_16x16x32_bf16 v[228:231], v[28:31], v[212:215], v[228:231]
    s_waitcnt vmcnt(1)
    v_max3_u32 v6, v216, v217, v218
    v_mfma_f32_16x16x32_bf16 v[232:235], v[32:35], v[212:215], v[232:235]
    v_max_u32 v6, v6, v219
    v_cmp_eq_u32_e64 vcc, -1, v6
    v_mfma_f32_16x16x32_bf16 v[236:239], v[36:39], v[212:215], v[236:239]
    s_cbranch_vccnz L_or12
L_og12:
    v_mfma_f32_16x16x32_bf16 v[224:227], v[40:43], v[216:219], v[224:227]
    v_mfma_f32_16x16x32_bf16 v[228:231], v[44:47], v[216:219], v[228:231]
    s_waitcnt vmcnt(0)
    v_max3_u32 v6, v220, v221, v222
    v_mfma_f32_16x16x32_bf16 v[232:235], v[48:51], v[216:219], v[232:235]
    v_max_u32 v6, v6, v223
    v_cmp_eq_u32 vcc, -1, v6
    v_mfma_f32_16x16x32_bf16 v[236:239], v[52:55], v[216:219], v[236:239]
    s_cbranch_vccnz L_or13
L_og13:
    v_mfma_f32_16x16x32_bf16 v[224:227], v[56:59], v[220:223], v[224:227]
    v_mfma_f32_16x16x32_bf16 v[228:231], v[60:63], v[220:223], v[228:231]
    v_mfma_f32_16x16x32_bf16 v[232:235], v[64:67], v[220:223], v[232:235]
    v_mfma_f32_16x16x32_bf16 v[236:239], v[68:71], v[220:223], v[236:239]
    s_nop 4
    v_cvt_pk_bf16_f32 v16, v224, v225
    v_cvt_pk_bf16_f32 v17, v226, v227
    v_cvt_pk_bf16_f32 v18, v228, v229
    v_cvt_pk_bf16_f32 v19, v230, v231
    v_cvt_pk_bf16_f32 v20, v232, v233
    v_cvt_pk_bf16_f32 v21, v234, v235
    v_cvt_pk_bf16_f32 v22, v236, v237
    v_cvt_pk_bf16_f32 v23, v238, v239
    ds_write_b128 v244, v[16:19]
    ds_write_b128 v5, v[20:23]
    ds_read_b128 v[24:27], v245
    ds_read_b128 v[28:31], v245 offset:1024
    s_or_b32 s65, s2, s31
    s_waitcnt lgkmcnt(1)
    buffer_store_dwordx4 v[24:27], v246, s[52:55], s80 offen sc1
    s_waitcnt lgkmcnt(0)
    buffer_store_dwordx4 v[28:31], v246, s[52:55], s81 offen sc1
    s_cbranch_scc1 L_noepoch
    v_mov_b32 v1, s37
    v_mov_b32 v6, 0
    s_mov_b64 exec, 1
    buffer_store_dword v1, v6, s[40:43], s65 offen sc1
    s_mov_b64 exec, -1
L_noepoch:
L_end:
    s_endpgm
    s_nop 0
L_or0:
    buffer_load_dwordx4 v[180:183], v242, s[40:43], s7 offen sc1
    buffer_load_dwordx4 v[184:187], v242, s[40:43], s8 offen sc1
    buffer_load_dwordx4 v[188:191], v242, s[40:43], s9 offen sc1
    buffer_load_dwordx4 v[192:195], v242, s[40:43], s10 offen sc1
    buffer_load_dwordx4 v[196:199], v242, s[40:43], s11 offen sc1
L_oc0:
    buffer_load_dwordx4 v[168:171], v242, s[40:43], s4 offen sc1
    buffer_load_dwordx4 v[172:175], v242, s[40:43], s5 offen sc1
    buffer_load_dwordx4 v[176:179], v242, s[40:43], s6 offen sc1
    s_sub_u32 s56, s56, 1
    s_cselect_b32 s56, 0, s56
    s_waitcnt vmcnt(0)
    s_cbranch_scc1 L_og0
    v_max3_u32 v6, v168, v169, v170
    v_max_u32 v6, v6, v171
    v_cmp_eq_u32 vcc, -1, v6
    s_cbranch_vccnz L_oc0
    s_branch L_og0
L_or1:
    buffer_load_dwordx4 v[184:187], v242, s[40:43], s8 offen sc1
    buffer_load_dwordx4 v[188:191], v242, s[40:43], s9 offen sc1
    buffer_load_dwordx4 v[192:195], v242, s[40:43], s10 offen sc1
    buffer_load_dwordx4 v[196:199], v242, s[40:43], s11 offen sc1
    buffer_load_dwordx4 v[200:203], v242, s[40:43], s12 offen sc1
L_oc1:
    buffer_load_dwordx4 v[172:175], v242, s[40:43], s5 offen sc1
    buffer_load_dwordx4 v[176:179], v242, s[40:43], s6 offen sc1
    buffer_load_dwordx4 v[180:183], v242, s[40:43], s7 offen sc1
    s_sub_u32 s56, s56, 1
    s_cselect_b32 s56, 0, s56
    s_waitcnt vmcnt(0)
    s_cbranch_scc1 L_og1
    v_max3_u32 v6, v172, v173, v174
    v_max_u32 v6, v6, v175
    v_cmp_eq_u32 vcc, -1, v6
    s_cbranch_vccnz L_oc1
    s_branch L_og1
L_or2:
    buffer_load_dwordx4 v[188:191], v242, s[40:43], s9 offen sc1
L_qad1:
    s_cbranch_execz L_qad_ret
    buffer_load_dwordx4 v[192:195], v242, s[40:43], s10 offen sc1
    buffer_load_dwordx4 v[196:199], v242, s[40:43], s11 offen sc1
    buffer_load_dwordx4 v[200:203], v242, s[40:43], s12 offen sc1
    buffer_load_dwordx4 v[204:207], v242, s[40:43], s13 offen sc1
L_oc2:
    buffer_load_dwordx4 v[176:179], v242, s[40:43], s6 offen sc1
    buffer_load_dwordx4 v[180:183], v242, s[40:43], s7 offen sc1
    buffer_load_dwordx4 v[184:187], v242, s[40:43], s8 offen sc1
    s_sub_u32 s56, s56, 1
    s_cselect_b32 s56, 0, s56
    s_waitcnt vmcnt(0)
    s_cbranch_scc1 L_og2
    v_max3_u32 v6, v176, v177, v178
    v_max_u32 v6, v6, v179
    v_cmp_eq_u32 vcc, -1, v6
    s_cbranch_vccnz L_oc2
    s_branch L_og2
    s_nop 0
L_or3:
    buffer_load_dwordx4 v[192:195], v242, s[40:43], s10 offen sc1
    buffer_load_dwordx4 v[196:199], v242, s[40:43], s11 offen sc1
    buffer_load_dwordx4 v[200:203], v242, s[40:43], s12 offen sc1
    buffer_load_dwordx4 v[204:207], v242, s[40:43], s13 offen sc1
    buffer_load_dwordx4 v[208:211], v242, s[40:43], s14 offen sc1
L_oc3:
    buffer_load_dwordx4 v[180:183], v242, s[40:43], s7 offen sc1
    buffer_load_dwordx4 v[184:187], v242, s[40:43], s8 offen sc1
    buffer_load_dwordx4 v[188:191], v242, s[40:43], s9 offen sc1
    s_sub_u32 s56, s56, 1
    s_cselect_b32 s56, 0, s56
    s_waitcnt vmcnt(0)
    s_cbranch_scc1 L_og3
    v_max3_u32 v6, v180, v181, v182
    v_max_u32 v6, v6, v183
    v_cmp_eq_u32 vcc, -1, v6
    s_cbranch_vccnz L_oc3
    s_branch L_og3
L_or4:
    buffer_load_dwordx4 v[196:199], v242, s[40:43], s11 offen sc1
    buffer_load_dwordx4 v[200:203], v242, s[40:43], s12 offen sc1
    buffer_load_dwordx4 v[204:207], v242, s[40:43], s13 offen sc1
    buffer_load_dwordx4 v[208:211], v242, s[40:43], s14 offen sc1
    buffer_load_dwordx4 v[212:215], v242, s[40:43], s15 offen sc1
L_oc4:
    buffer_load_dwordx4 v[184:187], v242, s[40:43], s8 offen sc1
    buffer_load_dwordx4 v[188:191], v242, s[40:43], s9 offen sc1
    buffer_load_dwordx4 v[192:195], v242, s[40:43], s10 offen sc1
    s_sub_u32 s56, s56, 1
    s_cselect_b32 s56, 0, s56
    s_waitcnt vmcnt(0)
    s_cbranch_scc1 L_og4
    v_max3_u32 v6, v184, v185, v186
    v_max_u32 v6, v6, v187
    v_cmp_eq_u32 vcc, -1, v6
    s_cbranch_vccnz L_oc4
    s_branch L_og4
L_or5:
    buffer_load_dwordx4 v[200:203], v242, s[40:43], s12 offen sc1
    buffer_load_dwordx4 v[204:207], v242, s[40:43], s13 offen sc1
    buffer_load_dwordx4 v[208:211], v242, s[40:43], s14 offen sc1
    buffer_load_dwordx4 v[212:215], v242, s[40:43], s15 offen sc1
    buffer_load_dwordx4 v[216:219], v242, s[40:43], s16 offen sc1
L_oc5:
    buffer_load_dwordx4 v[188:191], v242, s[40:43], s9 offen sc1
    buffer_load_dwordx4 v[192:195], v242, s[40:43], s10 offen sc1
    buffer_load_dwordx4 v[196:199], v242, s[40:43], s11 offen sc1
    s_sub_u32 s56, s56, 1
    s_cselect_b32 s56, 0, s56
    s_waitcnt vmcnt(0)
    s_cbranch_scc1 L_og5
    v_max3_u32 v6, v188, v189, v190
    v_max_u32 v6, v6, v191
    v_cmp_eq_u32 vcc, -1, v6
    s_cbranch_vccnz L_oc5
    s_branch L_og5
L_or6:
    buffer_load_dwordx4 v[204:207], v242, s[40:43], s13 offen sc1
    buffer_load_dwordx4 v[208:211], v242, s[40:43], s14 offen sc1
    buffer_load_dwordx4 v[212:215], v242, s[40:43], s15 offen sc1
    buffer_load_dwordx4 v[216:219], v242, s[40:43], s16 offen sc1
    buffer_load_dwordx4 v[220:223], v242, s[40:43], s17 offen sc1
L_oc6:
    buffer_load_dwordx4 v[192:195], v242, s[40:43], s10 offen sc1
    buffer_load_dwordx4 v[196:199], v242, s[40:43], s11 offen sc1
    buffer_load_dwordx4 v[200:203], v242, s[40:43], s12 offen sc1
    s_sub_u32 s56, s56, 1
    s_cselect_b32 s56, 0, s56
    s_waitcnt vmcnt(0)
    s_cbranch_scc1 L_og6
    v_max3_u32 v6, v192, v193, v194
    v_max_u32 v6, v6, v195
    v_cmp_eq_u32 vcc, -1, v6
    s_cbranch_vccnz L_oc6
    s_branch L_og6
L_or7:
    buffer_load_dwordx4 v[208:211], v242, s[40:43], s14 offen sc1
    buffer_load_dwordx4 v[212:215], v242, s[40:43], s15 offen sc1
    buffer_load_dwordx4 v[216:219], v242, s[40:43], s16 offen sc1
    buffer_load_dwordx4 v[220:223], v242, s[40:43], s17 offen sc1
L_oc7:
    buffer_load_dwordx4 v[196:199], v242, s[40:43], s11 offen sc1
    buffer_load_dwordx4 v[200:203], v242, s[40:43], s12 offen sc1
    buffer_load_dwordx4 v[204:207], v242, s[40:43], s13 offen sc1
    s_sub_u32 s56, s56, 1
    s_cselect_b32 s56, 0, s56
    s_waitcnt vmcnt(0)
    s_cbranch_scc1 L_og7
    v_max3_u32 v6, v196, v197, v198
    v_max_u32 v6, v6, v199
    v_cmp_eq_u32 vcc, -1, v6
    s_cbranch_vccnz L_oc7
    s_branch L_og7
L_or8:
    buffer_load_dwordx4 v[212:215], v242, s[40:43], s15 offen sc1
    buffer_load_dwordx4 v[216:219], v242, s[40:43], s16 offen sc1
    buffer_load_dwordx4 v[220:223], v242, s[40:43], s17 offen sc1
L_oc8:
    buffer_load_dwordx4 v[200:203], v242, s[40:43], s12 offen sc1
    buffer_load_dwordx4 v[204:207], v242, s[40:43], s13 offen sc1
    buffer_load_dwordx4 v[208:211], v242, s[40:43], s14 offen sc1
    s_sub_u32 s56, s56, 1
    s_cselect_b32 s56, 0, s56
    s_waitcnt vmcnt(0)
    s_cbranch_scc1 L_og8
    v_max3_u32 v6, v200, v201, v202
    v_max_u32 v6, v6, v203
    v_cmp_eq_u32 vcc, -1, v6
    s_cbranch_vccnz L_oc8
    s_branch L_og8
L_or9:
    buffer_load_dwordx4 v[216:219], v242, s[40:43], s16 offen sc1
    buffer_load_dwordx4 v[220:223], v242, s[40:43], s17 offen sc1
L_oc9:
    buffer_load_dwordx4 v[204:207], v242, s[40:43], s13 offen sc1
    buffer_load_dwordx4 v[208:211], v242, s[40:43], s14 offen sc1
    buffer_load_dwordx4 v[212:215], v242, s[40:43], s15 offen sc1
    s_sub_u32 s56, s56, 1
    s_cselect_b32 s56, 0, s56
    s_waitcnt vmcnt(0)
    s_cbranch_scc1 L_og9
    v_max3_u32 v6, v204, v205, v206
    v_max_u32 v6, v6, v207
    v_cmp_eq_u32 vcc, -1, v6
    s_cbranch_vccnz L_oc9
    s_branch L_og9
L_or10:
    buffer_load_dwordx4 v[220:223], v242, s[40:43], s17 offen sc1
L_oc10:
    buffer_load_dwordx4 v[208:211], v242, s[40:43], s14 offen sc1
    buffer_load_dwordx4 v[212:215], v242, s[40:43], s15 offen sc1
    buffer_load_dwordx4 v[216:219], v242, s[40:43], s16 offen sc1
    s_sub_u32 s56, s56, 1
    s_cselect_b32 s56, 0, s56
    s_waitcnt vmcnt(0)
    s_cbranch_scc1 L_og10
    v_max3_u32 v6, v208, v209, v210
    v_max_u32 v6, v6, v211
    v_cmp_eq_u32 vcc, -1, v6
    s_cbranch_vccnz L_oc10
    s_branch L_og10
L_or11:
L_oc11:
    buffer_load_dwordx4 v[212:215], v242, s[40:43], s15 offen sc1
    buffer_load_dwordx4 v[216:219], v242, s[40:43], s16 offen sc1
    buffer_load_dwordx4 v[220:223], v242, s[40:43], s17 offen sc1
    s_sub_u32 s56, s56, 1
    s_cselect_b32 s56, 0, s56
    s_waitcnt vmcnt(0)
    s_cbranch_scc1 L_og11
    v_max3_u32 v6, v212, v213, v214
    v_max_u32 v6, v6, v215
    v_cmp_eq_u32 vcc, -1, v6
    s_cbranch_vccnz L_oc11
    s_branch L_og11
L_or12:
L_oc12:
    buffer_load_dwordx4 v[216:219], v242, s[40:43], s16 offen sc1
    buffer_load_dwordx4 v[220:223], v242, s[40:43], s17 offen sc1
    s_sub_u32 s56, s56, 1
    s_cselect_b32 s56, 0, s56
    s_waitcnt vmcnt(0)
    s_cbranch_scc1 L_og12
    v_max3_u32 v6, v216, v217, v218
    v_max_u32 v6, v6, v219
    v_cmp_eq_u32 vcc, -1, v6
    s_cbranch_vccnz L_oc12
    s_branch L_og12
L_or13:
L_oc13:
    buffer_load_dwordx4 v[220:223], v242, s[40:43], s17 offen sc1
    s_sub_u32 s56, s56, 1
    s_cselect_b32 s56, 0, s56
    s_waitcnt vmcnt(0)
    s_cbranch_scc1 L_og13
    v_max3_u32 v6, v220, v221, v222
    v_max_u32 v6, v6, v223
    v_cmp_eq_u32 vcc, -1, v6
    s_cbranch_vccnz L_oc13
    s_branch L_og13
.p2align 12
L_mha1:
    s_mov_b64 exec, -1
    s_mov_b64 s[40:41], s[28:29]
    s_mov_b32 s42, 16777216
    s_mov_b32 s43, 0x20000
    v_and_b32 v24, 31, v0
L_pad0:
    s_cbranch_execz L_pad16
    v_lshrrev_b32 v19, 5, v0
    v_lshrrev_b32 v25, 1, v24
    v_xor_b32 v25, v25, v24
    v_and_b32 v25, 4, v25
    s_add_u32 m0, s68, 0
    s_add_u32 s88, s61, 0
    buffer_load_dwordx4 v5, s[48:51], s88 offen offset:0 lds
    v_mul_u32_u24 v25, 3, v25
    v_xor_b32 v18, v25, v24
    v_bfe_u32 v25, v18, 1, 3
    v_xor_b32 v25, v25, v19
    v_lshlrev_b32 v25, 4, v25
    v_lshl_add_u32 v25, v18, 7, v25
    v_add_u32 v11, s64, v25
    v_xor_b32 v12, 32, v11
    buffer_load_dwordx4 v6, s[48:51], s88 offen offset:1024 lds
    v_xor_b32 v13, 64, v11
    v_xor_b32 v14, 0x60, v11
    v_and_b32 v25, 3, v0
    v_lshrrev_b32 v26, 1, v25
    v_and_b32 v21, 1, v25
    v_lshl_or_b32 v26, v21, 1, v26
    v_bfe_u32 v21, v0, 4, 1
    v_lshl_or_b32 v25, v21, 2, v25
    s_add_u32 m0, s68, 8192
    s_add_u32 s89, s61, 172032
    buffer_load_dwordx4 v5, s[48:51], s89 offen offset:0 lds
    v_lshl_or_b32 v26, v21, 2, v26
    v_bfe_u32 v21, v0, 2, 2
    v_lshl_or_b32 v23, v19, 3, v21
    v_lshlrev_b32_e64 v22, 6, v23
    v_lshl_add_u32 v22, v26, 3, v22
    v_add_u32 v22, 118784, v22
    s_cmp_eq_u32 s32, 0
    s_cselect_b64 vcc, -1, 0
    buffer_load_dwordx4 v6, s[48:51], s89 offen offset:1024 lds
    v_cndmask_b32 v25, v25, v26, vcc
    v_lshlrev_b32 v15, 7, v23
    v_lshl_add_u32 v15, v25, 3, v15
    v_lshrrev_b32 v21, 1, v21
    v_lshl_add_u32 v15, v21, 6, v15
    v_add_u32 v16, 57344, v15
    v_lshlrev_b32 v25, 4, v18
    v_mad_u32_u24 v25, v19, s57, v25
    s_add_u32 m0, s68, 16384
    s_add_u32 s90, s61, 344064
    buffer_load_dwordx4 v5, s[48:51], s90 offen offset:0 lds
    v_lshrrev_b32 v26, 2, v24
    v_mul_u32_u24 v26, 16384, v26
    v_lshl_add_u32 v26, v19, 6, v26
    v_and_b32 v21, 3, v24
    v_lshl_add_u32 v26, v21, 4, v26
    v_cndmask_b32 v20, v26, v25, vcc
    s_lshl2_add_u32 s65, s34, s31
    s_lshl_b32 s66, s65, 9
    buffer_load_dwordx4 v6, s[48:51], s90 offen offset:1024 lds
    s_add_u32 s66, s66, 1048576
    s_lshl_b32 s65, s65, 8
    s_add_u32 s65, s65, 3145728
    s_movk_i32 s69, 128
    s_cmp_eq_u32 s32, 0
    s_cselect_b32 s67, s66, s65
    s_cselect_b32 s69, 65536, s69
    s_mul_i32 s65, s33, 262144
    s_add_u32 m0, s68, 24576
    s_add_u32 s91, s61, 516096
    buffer_load_dwordx4 v5, s[48:51], s91 offen offset:0 lds
    s_add_u32 s67, s67, s65
    v_lshrrev_b32 v25, 2, v0
    v_mul_u32_u24 v25, 2688, v25
    v_lshl_add_u32 v21, v21, 4, v25
    s_lshl_b32 s82, s38, 4
    s_mul_i32 s65, s31, 43008
    s_add_u32 s82, s82, s65
    s_lshr_b32 s65, s38, 3
    buffer_load_dwordx4 v6, s[48:51], s91 offen offset:1024 lds
    s_add_u32 s66, s38, 3
    s_lshr_b32 s66, s66, 3
    s_sub_u32 s66, s66, s65
    v_bfe_u32 v26, v0, 4, 1
    v_mul_u32_u24 v26, s66, v26
    v_lshl_add_u32 v26, v19, 3, v26
    v_add_u32 v26, s65, v26
    v_and_b32 v25, 15, v0
    s_add_u32 m0, s68, 32768
    s_add_u32 s92, s61, 688128
    buffer_load_dwordx4 v5, s[48:51], s92 offen offset:0 lds
    v_cmp_lt_u32 vcc, 7, v25
    v_and_b32 v25, 3, v0
    v_lshl_add_u32 v26, v26, 6, v25
    s_lshl_b32 s65, s31, 2
    v_add_u32 v26, s65, v26
    v_lshlrev_b32 v26, 7, v26
    v_add_u32 v23, 4096, v26
    s_and_b32 s65, s2, 7
    buffer_load_dwordx4 v6, s[48:51], s92 offen offset:1024 lds
    s_lshl2_add_u32 s65, s65, s31
    s_lshl3_add_u32 s65, s65, s32
    s_mul_i32 s65, s65, 128
    s_add_u32 s65, s65, 266240
    v_mul_u32_u24 v25, 256, v25
    v_add_u32 v25, s65, v25
    v_cndmask_b32 v23, v23, v25, vcc
    v_lshlrev_b32_e64 v27, 4, v24
    s_add_u32 m0, s68, 40960
    s_add_u32 s93, s61, 860160
    buffer_load_dwordx4 v5, s[48:51], s93 offen offset:0 lds
    v_mad_u32_u24 v27, v19, s57, v27
    v_add_u32 v28, 65536, v27
    v_lshrrev_b32 v24, 2, v18
    s_bitcmp1_b32 s36, 0
    s_cselect_b32 s65, 0, 7
    v_cmp_eq_u32 vcc, s65, v24
    s_lshl_b32 s65, s38, 1
    s_sub_u32 s65, s32, s65
    buffer_load_dwordx4 v6, s[48:51], s93 offen offset:1024 lds
    s_add_u32 s65, s65, 112
    v_mov_b32 v25, s65
    v_cndmask_b32 v24, v24, v25, vcc
    v_mul_u32_u24 v24, 16384, v24
    v_lshl_add_u32 v24, v19, 6, v24
    v_and_b32_e64 v25, 3, v0
    v_lshl_add_u32 v29, v25, 4, v24
    v_mov_b32 v30, 0xdddddddd
    s_add_u32 m0, s68, 49152
    s_add_u32 s94, s61, 1032192
    buffer_load_dwordx4 v5, s[48:51], s94 offen offset:0 lds
    s_mul_i32 s65, s38, 32768
    s_lshl_b32 s71, s31, 13
    s_add_u32 s71, s71, s65
    s_add_u32 s71, s71, 1048576
    s_lshl_b32 s72, s31, 12
    s_add_u32 s72, s72, s65
    s_add_u32 s72, s72, 3145728
    s_lshl2_add_u32 s66, s34, s31
    buffer_load_dwordx4 v6, s[48:51], s94 offen offset:1024 lds
    s_lshl_b32 s66, s66, 9
    s_add_u32 s85, s65, s66
    s_add_u32 s85, s85, 5242880
    s_add_u32 s86, s85, 65536
    s_bitcmp1_b32 s36, 0
    s_cselect_b64 s[76:77], -1, 0
    v_mov_b32 v26, 0x3e8b97f6
    v_cmp_gt_u32 vcc, 32, v0
    s_add_u32 m0, s64, 3968
    s_nop 0
    buffer_load_dwordx4 v7, s[44:47], s60 offen offset:128 lds
    s_and_b64 s[78:79], vcc, s[76:77]
    s_nor_b64 s[80:81], vcc, s[76:77]
    v_cndmask_b32 v24, v26, 0, s[78:79]
    v_cndmask_b32 v25, v26, 0, s[80:81]
    s_mov_b32 s78, 0x3f803f80
    s_mov_b32 s79, s78
    v_xor_b32 v17, 64, v16
    v_subrev_u32 v15, 61440, v22
    buffer_load_dwordx4 v8, s[44:47], s60 offen offset:1152 lds
    s_lshl_b32 s74, s31, 10
    s_add_u32 s74, s74, 57344
    v_lshlrev_b32_e64 v18, 4, v18
    v_mad_u32_u24 v18, v19, s57, v18
    v_lshl_add_u32 v19, v0, 4, s64
    buffer_load_dwordx4 v9, s[44:47], s60 offen offset:2176 lds
    buffer_load_dwordx4 v10, s[44:47], s60 offen offset:3200 lds
    s_add_u32 m0, s64, 7936
    s_nop 0
    buffer_load_dwordx4 v7, s[44:47], s60 offen offset:256 lds
    buffer_load_dwordx4 v8, s[44:47], s60 offen offset:1280 lds
    buffer_load_dwordx4 v9, s[44:47], s60 offen offset:2304 lds
    buffer_load_dwordx4 v10, s[44:47], s60 offen offset:3328 lds
    s_waitcnt vmcnt(22)
    ds_read_b128 v[144:147], v11 offset:0
    ds_read_b128 v[148:151], v12 offset:0
    ds_read_b128 v[152:155], v13 offset:0
    ds_read_b128 v[156:159], v14 offset:0
    s_waitcnt vmcnt(8) lgkmcnt(0)
    v_mov_b32 v1, 1
    ds_write_b32 v2, v1
    s_add_u32 m0, s64, -384
    s_nop 0
    buffer_load_dwordx4 v7, s[44:47], s60 offen offset:384 lds
    buffer_load_dwordx4 v8, s[44:47], s60 offen offset:1408 lds
    buffer_load_dwordx4 v9, s[44:47], s60 offen offset:2432 lds
    buffer_load_dwordx4 v10, s[44:47], s60 offen offset:3456 lds
    s_waitcnt vmcnt(8)
    ds_read_b128 v[160:163], v11 offset:4096
    ds_read_b128 v[164:167], v12 offset:4096
    ds_read_b128 v[168:171], v13 offset:4096
    ds_read_b128 v[172:175], v14 offset:4096
L_lw_1:
    ds_read_b32 v1, v3
    s_waitcnt lgkmcnt(0)
    v_cmp_gt_u32 vcc, 1, v1
    s_cbranch_vccnz L_lw_1
    s_add_u32 s37, s37, 0x9e3779b9
    ds_read_b64_tr_b16 v[32:33], v16 offset:0
L_pad1:
    s_cbranch_execz L_pad17
    ds_read_b64_tr_b16 v[34:35], v16 offset:512
    ds_read_b64_tr_b16 v[36:37], v17 offset:0
    ds_read_b64_tr_b16 v[38:39], v17 offset:512
    ds_read_b64_tr_b16 v[40:41], v16 offset:2048
    ds_read_b64_tr_b16 v[42:43], v16 offset:2560
    ds_read_b64_tr_b16 v[44:45], v17 offset:2048
    ds_read_b64_tr_b16 v[46:47], v17 offset:2560
    ds_read_b64_tr_b16 v[48:49], v16 offset:4096
    ds_read_b64_tr_b16 v[50:51], v16 offset:4608
    ds_read_b64_tr_b16 v[52:53], v17 offset:4096
    ds_read_b64_tr_b16 v[54:55], v17 offset:4608
    ds_read_b64_tr_b16 v[56:57], v16 offset:6144
    ds_read_b64_tr_b16 v[58:59], v16 offset:6656
    ds_read_b64_tr_b16 v[60:61], v17 offset:6144
    ds_read_b64_tr_b16 v[62:63], v17 offset:6656
    s_waitcnt lgkmcnt(0)
    s_cmp_lg_u32 s32, 0
    s_cbranch_scc1 L_gemm_v
    s_nop 0
    s_add_u32 m0, s64, 3584
    v_mfma_f32_32x32x16_bf16 v[96:111], v[32:35], v[144:147], 0
    buffer_load_dwordx4 v7, s[44:47], s60 offen offset:512 lds
    ds_read_b64_tr_b16 v[64:65], v16 offset:8192
    ds_read_b64_tr_b16 v[66:67], v16 offset:8704
    ds_read_b64_tr_b16 v[68:69], v17 offset:8192
    v_mfma_f32_32x32x16_bf16 v[112:127], v[36:39], v[144:147], 0
    buffer_load_dwordx4 v8, s[44:47], s60 offen offset:1536 lds
    ds_read_b64_tr_b16 v[70:71], v17 offset:8704
    ds_read_b64_tr_b16 v[72:73], v16 offset:10240
    ds_read_b64_tr_b16 v[74:75], v16 offset:10752
    v_mfma_f32_32x32x16_bf16 v[96:111], v[40:43], v[148:151], v[96:111]
    buffer_load_dwordx4 v9, s[44:47], s60 offen offset:2560 lds
    ds_read_b64_tr_b16 v[76:77], v17 offset:10240
    ds_read_b64_tr_b16 v[78:79], v17 offset:10752
    ds_read_b64_tr_b16 v[80:81], v16 offset:12288
    v_mfma_f32_32x32x16_bf16 v[112:127], v[44:47], v[148:151], v[112:127]
    buffer_load_dwordx4 v10, s[44:47], s60 offen offset:3584 lds
    ds_read_b64_tr_b16 v[82:83], v16 offset:12800
    ds_read_b64_tr_b16 v[84:85], v17 offset:12288
    ds_read_b64_tr_b16 v[86:87], v17 offset:12800
    v_mfma_f32_32x32x16_bf16 v[96:111], v[48:51], v[152:155], v[96:111]
    ds_read_b64_tr_b16 v[88:89], v16 offset:14336
    ds_read_b64_tr_b16 v[90:91], v16 offset:14848
    ds_read_b64_tr_b16 v[92:93], v17 offset:14336
    ds_read_b64_tr_b16 v[94:95], v17 offset:14848
    v_mfma_f32_32x32x16_bf16 v[112:127], v[52:55], v[152:155], v[112:127]
    s_waitcnt vmcnt(8)
    ds_read_b128 v[176:179], v11 offset:8192
    ds_read_b128 v[180:183], v12 offset:8192
    ds_read_b128 v[184:187], v13 offset:8192
    ds_read_b128 v[188:191], v14 offset:8192
    v_mfma_f32_32x32x16_bf16 v[96:111], v[56:59], v[156:159], v[96:111]
    v_mfma_f32_32x32x16_bf16 v[112:127], v[60:63], v[156:159], v[112:127]
    s_waitcnt lgkmcnt(0)
    v_mov_b32_e64 v1, 2
    ds_write_b32 v2, v1
    s_add_u32 m0, s64, 7552
    v_mfma_f32_32x32x16_bf16 v[96:111], v[64:67], v[160:163], v[96:111]
    buffer_load_dwordx4 v7, s[44:47], s60 offen offset:640 lds
    ds_read_b64_tr_b16 v[32:33], v16 offset:16384
    ds_read_b64_tr_b16 v[34:35], v16 offset:16896
    ds_read_b64_tr_b16 v[36:37], v17 offset:16384
    v_mfma_f32_32x32x16_bf16 v[112:127], v[68:71], v[160:163], v[112:127]
    buffer_load_dwordx4 v8, s[44:47], s60 offen offset:1664 lds
    ds_read_b64_tr_b16 v[38:39], v17 offset:16896
    ds_read_b64_tr_b16 v[40:41], v16 offset:18432
    ds_read_b64_tr_b16 v[42:43], v16 offset:18944
    v_mfma_f32_32x32x16_bf16 v[96:111], v[72:75], v[164:167], v[96:111]
    buffer_load_dwordx4 v9, s[44:47], s60 offen offset:2688 lds
    ds_read_b64_tr_b16 v[44:45], v17 offset:18432
    ds_read_b64_tr_b16 v[46:47], v17 offset:18944
    ds_read_b64_tr_b16 v[48:49], v16 offset:20480
    v_mfma_f32_32x32x16_bf16 v[112:127], v[76:79], v[164:167], v[112:127]
    buffer_load_dwordx4 v10, s[44:47], s60 offen offset:3712 lds
    ds_read_b64_tr_b16 v[50:51], v16 offset:20992
    ds_read_b64_tr_b16 v[52:53], v17 offset:20480
    ds_read_b64_tr_b16 v[54:55], v17 offset:20992
    v_mfma_f32_32x32x16_bf16 v[96:111], v[80:83], v[168:171], v[96:111]
    ds_read_b64_tr_b16 v[56:57], v16 offset:22528
    ds_read_b64_tr_b16 v[58:59], v16 offset:23040
    ds_read_b64_tr_b16 v[60:61], v17 offset:22528
    ds_read_b64_tr_b16 v[62:63], v17 offset:23040
    ds_read_b32 v31, v3
    v_mfma_f32_32x32x16_bf16 v[112:127], v[84:87], v[168:171], v[112:127]
    s_add_u32 m0, s74, 0
    s_add_u32 s83, s82, 0
    s_waitcnt vmcnt(8)
    ds_read_b128 v[192:195], v11 offset:0
    ds_read_b128 v[196:199], v12 offset:0
    ds_read_b128 v[200:203], v13 offset:0
    ds_read_b128 v[204:207], v14 offset:0
    v_mfma_f32_32x32x16_bf16 v[96:111], v[88:91], v[172:175], v[96:111]
    s_waitcnt lgkmcnt(4)
    v_cmp_gt_u32 vcc, 2, v31
    s_cbranch_vccz L_w2_k1
L_w1_k1:
    ds_read_b32 v31, v3
    s_waitcnt lgkmcnt(0)
    v_cmp_gt_u32_e64 vcc, 2, v31
    s_cbranch_vccnz L_w1_k1
L_w2_k1:
    buffer_load_dwordx4 v21, s[48:51], s83 offen lds
    s_add_u32 m0, s74, 4096
    s_add_u32 s83, s82, 172032
    v_mfma_f32_32x32x16_bf16 v[112:127], v[92:95], v[172:175], v[112:127]
    buffer_load_dwordx4 v21, s[48:51], s83 offen lds
    s_waitcnt lgkmcnt(0)
    s_nop 0
    s_add_u32 m0, s64, -768
    v_mfma_f32_32x32x16_bf16 v[96:111], v[32:35], v[176:179], v[96:111]
    buffer_load_dwordx4 v7, s[44:47], s60 offen offset:768 lds
    ds_read_b64_tr_b16 v[64:65], v16 offset:24576
    ds_read_b64_tr_b16 v[66:67], v16 offset:25088
    ds_read_b64_tr_b16 v[68:69], v17 offset:24576
    v_mfma_f32_32x32x16_bf16 v[112:127], v[36:39], v[176:179], v[112:127]
    buffer_load_dwordx4 v8, s[44:47], s60 offen offset:1792 lds
    ds_read_b64_tr_b16 v[70:71], v17 offset:25088
    ds_read_b64_tr_b16 v[72:73], v16 offset:26624
    ds_read_b64_tr_b16 v[74:75], v16 offset:27136
    v_mfma_f32_32x32x16_bf16 v[96:111], v[40:43], v[180:183], v[96:111]
    buffer_load_dwordx4 v9, s[44:47], s60 offen offset:2816 lds
    ds_read_b64_tr_b16 v[76:77], v17 offset:26624
    ds_read_b64_tr_b16 v[78:79], v17 offset:27136
    ds_read_b64_tr_b16 v[80:81], v16 offset:28672
    v_mfma_f32_32x32x16_bf16 v[112:127], v[44:47], v[180:183], v[112:127]
    buffer_load_dwordx4 v10, s[44:47], s60 offen offset:3840 lds
    ds_read_b64_tr_b16 v[82:83], v16 offset:29184
    ds_read_b64_tr_b16 v[84:85], v17 offset:28672
    ds_read_b64_tr_b16 v[86:87], v17 offset:29184
    v_mfma_f32_32x32x16_bf16 v[96:111], v[48:51], v[184:187], v[96:111]
    ds_read_b64_tr_b16 v[88:89], v16 offset:30720
    ds_read_b64_tr_b16 v[90:91], v16 offset:31232
    ds_read_b64_tr_b16 v[92:93], v17 offset:30720
    ds_read_b64_tr_b16 v[94:95], v17 offset:31232
    v_mfma_f32_32x32x16_bf16 v[112:127], v[52:55], v[184:187], v[112:127]
    s_add_u32 m0, s74, 8192
    s_add_u32 s83, s82, 344064
    s_waitcnt vmcnt(10)
    ds_read_b128 v[208:211], v11 offset:4096
    ds_read_b128 v[212:215], v12 offset:4096
    ds_read_b128 v[216:219], v13 offset:4096
    ds_read_b128 v[220:223], v14 offset:4096
    v_mfma_f32_32x32x16_bf16 v[96:111], v[56:59], v[188:191], v[96:111]
    buffer_load_dwordx4 v21, s[48:51], s83 offen lds
L_pad2:
    s_cbranch_execz L_pad18
    s_add_u32 m0, s74, 12288
    s_add_u32 s83, s82, 516096
    v_mfma_f32_32x32x16_bf16 v[112:127], v[60:63], v[188:191], v[112:127]
    buffer_load_dwordx4 v21, s[48:51], s83 offen lds
    s_waitcnt lgkmcnt(0)
    s_nop 0
    s_add_u32 m0, s64, 4096
    s_add_u32 s83, s82, 688128
    v_mfma_f32_32x32x16_bf16 v[96:111], v[64:67], v[192:195], v[96:111]
    buffer_load_dwordx4 v21, s[48:51], s83 offen lds
    s_add_u32 m0, s64, 5120
    s_add_u32 s83, s82, 860160
    ds_read_b64_tr_b16 v[32:33], v16 offset:32768
    ds_read_b64_tr_b16 v[34:35], v16 offset:33280
    ds_read_b64_tr_b16 v[36:37], v17 offset:32768
    v_mfma_f32_32x32x16_bf16 v[112:127], v[68:71], v[192:195], v[112:127]
    buffer_load_dwordx4 v21, s[48:51], s83 offen lds
    s_add_u32 m0, s64, 6144
    s_add_u32 s83, s82, 1032192
    ds_read_b64_tr_b16 v[38:39], v17 offset:33280
    ds_read_b64_tr_b16 v[40:41], v16 offset:34816
    ds_read_b64_tr_b16 v[42:43], v16 offset:35328
    v_mfma_f32_32x32x16_bf16 v[96:111], v[72:75], v[196:199], v[96:111]
    buffer_load_dwordx4 v21, s[48:51], s83 offen lds
    ds_read_b64_tr_b16 v[44:45], v17 offset:34816
    ds_read_b64_tr_b16 v[46:47], v17 offset:35328
    ds_read_b64_tr_b16 v[48:49], v16 offset:36864
    v_mfma_f32_32x32x16_bf16 v[112:127], v[76:79], v[196:199], v[112:127]
    ds_read_b64_tr_b16 v[50:51], v16 offset:37376
    ds_read_b64_tr_b16 v[52:53], v17 offset:36864
    ds_read_b64_tr_b16 v[54:55], v17 offset:37376
    v_mfma_f32_32x32x16_bf16 v[96:111], v[80:83], v[200:203], v[96:111]
    ds_read_b64_tr_b16 v[56:57], v16 offset:38912
    ds_read_b64_tr_b16 v[58:59], v16 offset:39424
    ds_read_b64_tr_b16 v[60:61], v17 offset:38912
    ds_read_b64_tr_b16 v[62:63], v17 offset:39424
    v_mfma_f32_32x32x16_bf16 v[112:127], v[84:87], v[200:203], v[112:127]
    s_waitcnt vmcnt(11)
    ds_read_b128 v[224:227], v11 offset:8192
    ds_read_b128 v[228:231], v12 offset:8192
    ds_read_b128 v[232:235], v13 offset:8192
    ds_read_b128 v[236:239], v14 offset:8192
    v_mfma_f32_32x32x16_bf16 v[96:111], v[88:91], v[204:207], v[96:111]
    v_mfma_f32_32x32x16_bf16 v[112:127], v[92:95], v[204:207], v[112:127]
    s_waitcnt lgkmcnt(0)
    v_mfma_f32_32x32x16_bf16 v[96:111], v[32:35], v[208:211], v[96:111]
    ds_read_b64_tr_b16 v[64:65], v16 offset:40960
    ds_read_b64_tr_b16 v[66:67], v16 offset:41472
    ds_read_b64_tr_b16 v[68:69], v17 offset:40960
    v_mfma_f32_32x32x16_bf16 v[112:127], v[36:39], v[208:211], v[112:127]
    ds_read_b64_tr_b16 v[70:71], v17 offset:41472
    ds_read_b64_tr_b16 v[72:73], v16 offset:43008
    ds_read_b64_tr_b16 v[74:75], v16 offset:43520
    v_mfma_f32_32x32x16_bf16 v[96:111], v[40:43], v[212:215], v[96:111]
    ds_read_b64_tr_b16 v[76:77], v17 offset:43008
    ds_read_b64_tr_b16 v[78:79], v17 offset:43520
    ds_read_b64_tr_b16 v[80:81], v16 offset:45056
    v_mfma_f32_32x32x16_bf16 v[112:127], v[44:47], v[212:215], v[112:127]
    ds_read_b64_tr_b16 v[82:83], v16 offset:45568
    ds_read_b64_tr_b16 v[84:85], v17 offset:45056
    ds_read_b64_tr_b16 v[86:87], v17 offset:45568
    v_mfma_f32_32x32x16_bf16 v[96:111], v[48:51], v[216:219], v[96:111]
    ds_read_b64_tr_b16 v[88:89], v16 offset:47104
    ds_read_b64_tr_b16 v[90:91], v16 offset:47616
    ds_read_b64_tr_b16 v[92:93], v17 offset:47104
    ds_read_b64_tr_b16 v[94:95], v17 offset:47616
    v_mfma_f32_32x32x16_bf16 v[112:127], v[52:55], v[216:219], v[112:127]
    s_waitcnt vmcnt(5)
    ds_read_b128 v[240:243], v11 offset:0
    ds_read_b128 v[244:247], v12 offset:0
    ds_read_b128 v[248:251], v13 offset:0
    ds_read_b128 v[252:255], v14 offset:0
    v_mfma_f32_32x32x16_bf16 v[96:111], v[56:59], v[220:223], v[96:111]
    v_mfma_f32_32x32x16_bf16 v[112:127], v[60:63], v[220:223], v[112:127]
    s_waitcnt lgkmcnt(4)
    v_mfma_f32_32x32x16_bf16 v[96:111], v[64:67], v[224:227], v[96:111]
    ds_read_b64_tr_b16 v[32:33], v16 offset:49152
    ds_read_b64_tr_b16 v[34:35], v16 offset:49664
    ds_read_b64_tr_b16 v[36:37], v17 offset:49152
    v_mfma_f32_32x32x16_bf16 v[112:127], v[68:71], v[224:227], v[112:127]
    ds_read_b64_tr_b16 v[38:39], v17 offset:49664
    ds_read_b64_tr_b16 v[40:41], v16 offset:51200
    ds_read_b64_tr_b16 v[42:43], v16 offset:51712
    v_mfma_f32_32x32x16_bf16 v[96:111], v[72:75], v[228:231], v[96:111]
    ds_read_b64_tr_b16 v[44:45], v17 offset:51200
    ds_read_b64_tr_b16 v[46:47], v17 offset:51712
    ds_read_b64_tr_b16 v[48:49], v16 offset:53248
    v_mfma_f32_32x32x16_bf16 v[112:127], v[76:79], v[228:231], v[112:127]
    ds_read_b64_tr_b16 v[50:51], v16 offset:53760
    ds_read_b64_tr_b16 v[52:53], v17 offset:53248
    ds_read_b64_tr_b16 v[54:55], v17 offset:53760
    v_mfma_f32_32x32x16_bf16 v[96:111], v[80:83], v[232:235], v[96:111]
    ds_read_b64_tr_b16 v[56:57], v16 offset:55296
    ds_read_b64_tr_b16 v[58:59], v16 offset:55808
    ds_read_b64_tr_b16 v[60:61], v17 offset:55296
    ds_read_b64_tr_b16 v[62:63], v17 offset:55808
    v_mfma_f32_32x32x16_bf16 v[112:127], v[84:87], v[232:235], v[112:127]
    ds_read_b32 v31, v3 offset:16
    v_mfma_f32_32x32x16_bf16 v[96:111], v[88:91], v[236:239], v[96:111]
    s_add_u32 s68, s67, s69
    s_add_u32 s60, s67, 131072
    s_add_u32 s63, s68, 131072
    v_mfma_f32_32x32x16_bf16 v[112:127], v[92:95], v[236:239], v[112:127]
    s_waitcnt lgkmcnt(0)
    v_mfma_f32_32x32x16_bf16 v[96:111], v[32:35], v[240:243], v[96:111]
L_ec_k6:
    s_waitcnt lgkmcnt(0)
    v_cmp_gt_u32 vcc, 1, v31
    ds_read_b32 v31, v3 offset:16
    s_cbranch_vccnz L_ec_k6
    v_mfma_f32_32x32x16_bf16 v[96:111], v[40:43], v[244:247], v[96:111]
    v_mfma_f32_32x32x16_bf16 v[96:111], v[48:51], v[248:251], v[96:111]
    v_mfma_f32_32x32x16_bf16 v[96:111], v[56:59], v[252:255], v[96:111]
    v_mfma_f32_32x32x16_bf16 v[112:127], v[36:39], v[240:243], v[112:127]
    s_nop 4
    v_mfma_f32_32x32x16_bf16 v[112:127], v[44:47], v[244:247], v[112:127]
    s_nop 3
    v_mfma_f32_32x32x16_bf16 v[112:127], v[52:55], v[248:251], v[112:127]
    v_cvt_pk_bf16_f32 v128, v96, v97
    v_cvt_pk_bf16_f32 v129, v98, v99
    v_cvt_pk_bf16_f32 v130, v100, v101
    v_cvt_pk_bf16_f32 v131, v102, v103
    buffer_store_dwordx4 v[128:131], v20, s[40:43], s67 offen sc1
    v_mfma_f32_32x32x16_bf16 v[112:127], v[60:63], v[252:255], v[112:127]
    s_branch L_gemm_done
L_sp0:
    s_branch L_mha1
L_gemm_v:
L_pad3:
    s_cbranch_execz L_pad19
    s_add_u32 m0, s64, 3584
    v_mfma_f32_32x32x16_bf16 v[96:111], v[144:147], v[32:35], 0
    buffer_load_dwordx4 v7, s[44:47], s60 offen offset:512 lds
    ds_read_b64_tr_b16 v[64:65], v16 offset:8192
    ds_read_b64_tr_b16 v[66:67], v16 offset:8704
    ds_read_b64_tr_b16 v[68:69], v17 offset:8192
    v_mfma_f32_32x32x16_bf16 v[112:127], v[144:147], v[36:39], 0
    buffer_load_dwordx4 v8, s[44:47], s60 offen offset:1536 lds
    ds_read_b64_tr_b16 v[70:71], v17 offset:8704
    ds_read_b64_tr_b16 v[72:73], v16 offset:10240
    ds_read_b64_tr_b16 v[74:75], v16 offset:10752
    v_mfma_f32_32x32x16_bf16 v[96:111], v[148:151], v[40:43], v[96:111]
    buffer_load_dwordx4 v9, s[44:47], s60 offen offset:2560 lds
    ds_read_b64_tr_b16 v[76:77], v17 offset:10240
    ds_read_b64_tr_b16 v[78:79], v17 offset:10752
    ds_read_b64_tr_b16 v[80:81], v16 offset:12288
    v_mfma_f32_32x32x16_bf16 v[112:127], v[148:151], v[44:47], v[112:127]
    buffer_load_dwordx4 v10, s[44:47], s60 offen offset:3584 lds
    ds_read_b64_tr_b16 v[82:83], v16 offset:12800
    ds_read_b64_tr_b16 v[84:85], v17 offset:12288
    ds_read_b64_tr_b16 v[86:87], v17 offset:12800
    v_mfma_f32_32x32x16_bf16 v[96:111], v[152:155], v[48:51], v[96:111]
    ds_read_b64_tr_b16 v[88:89], v16 offset:14336
    ds_read_b64_tr_b16 v[90:91], v16 offset:14848
    ds_read_b64_tr_b16 v[92:93], v17 offset:14336
    ds_read_b64_tr_b16 v[94:95], v17 offset:14848
    v_mfma_f32_32x32x16_bf16 v[112:127], v[152:155], v[52:55], v[112:127]
    s_waitcnt vmcnt(8)
    ds_read_b128 v[176:179], v11 offset:8192
    ds_read_b128 v[180:183], v12 offset:8192
    ds_read_b128 v[184:187], v13 offset:8192
    ds_read_b128 v[188:191], v14 offset:8192
    v_mfma_f32_32x32x16_bf16 v[96:111], v[156:159], v[56:59], v[96:111]
    v_mfma_f32_32x32x16_bf16 v[112:127], v[156:159], v[60:63], v[112:127]
    s_waitcnt lgkmcnt(0)
    v_mov_b32_e64 v1, 2
    ds_write_b32 v2, v1
    s_add_u32 m0, s64, 7552
    v_mfma_f32_32x32x16_bf16 v[96:111], v[160:163], v[64:67], v[96:111]
    buffer_load_dwordx4 v7, s[44:47], s60 offen offset:640 lds
    ds_read_b64_tr_b16 v[32:33], v16 offset:16384
    ds_read_b64_tr_b16 v[34:35], v16 offset:16896
    ds_read_b64_tr_b16 v[36:37], v17 offset:16384
    v_mfma_f32_32x32x16_bf16 v[112:127], v[160:163], v[68:71], v[112:127]
    buffer_load_dwordx4 v8, s[44:47], s60 offen offset:1664 lds
    ds_read_b64_tr_b16 v[38:39], v17 offset:16896
    ds_read_b64_tr_b16 v[40:41], v16 offset:18432
    ds_read_b64_tr_b16 v[42:43], v16 offset:18944
    v_mfma_f32_32x32x16_bf16 v[96:111], v[164:167], v[72:75], v[96:111]
    buffer_load_dwordx4 v9, s[44:47], s60 offen offset:2688 lds
    ds_read_b64_tr_b16 v[44:45], v17 offset:18432
    ds_read_b64_tr_b16 v[46:47], v17 offset:18944
    ds_read_b64_tr_b16 v[48:49], v16 offset:20480
    v_mfma_f32_32x32x16_bf16 v[112:127], v[164:167], v[76:79], v[112:127]
    buffer_load_dwordx4 v10, s[44:47], s60 offen offset:3712 lds
    ds_read_b64_tr_b16 v[50:51], v16 offset:20992
    ds_read_b64_tr_b16 v[52:53], v17 offset:20480
    ds_read_b64_tr_b16 v[54:55], v17 offset:20992
    v_mfma_f32_32x32x16_bf16 v[96:111], v[168:171], v[80:83], v[96:111]
    ds_read_b64_tr_b16 v[56:57], v16 offset:22528
    ds_read_b64_tr_b16 v[58:59], v16 offset:23040
    ds_read_b64_tr_b16 v[60:61], v17 offset:22528
    ds_read_b64_tr_b16 v[62:63], v17 offset:23040
    ds_read_b32 v31, v3
    v_mfma_f32_32x32x16_bf16 v[112:127], v[168:171], v[84:87], v[112:127]
    s_add_u32 m0, s74, 0
    s_add_u32 s83, s82, 0
    s_waitcnt vmcnt(8)
    ds_read_b128 v[192:195], v11 offset:0
    ds_read_b128 v[196:199], v12 offset:0
    ds_read_b128 v[200:203], v13 offset:0
    ds_read_b128 v[204:207], v14 offset:0
    v_mfma_f32_32x32x16_bf16 v[96:111], v[172:175], v[88:91], v[96:111]
    s_waitcnt lgkmcnt(4)
    v_cmp_gt_u32 vcc, 2, v31
    s_cbranch_vccz L_w2_v1
L_w1_v1:
    ds_read_b32 v31, v3
    s_waitcnt lgkmcnt(0)
    v_cmp_gt_u32_e64 vcc, 2, v31
    s_cbranch_vccnz L_w1_v1
L_w2_v1:
    buffer_load_dwordx4 v21, s[48:51], s83 offen lds
    s_add_u32 m0, s74, 4096
    s_add_u32 s83, s82, 172032
    v_mfma_f32_32x32x16_bf16 v[112:127], v[172:175], v[92:95], v[112:127]
    buffer_load_dwordx4 v21, s[48:51], s83 offen lds
    s_waitcnt lgkmcnt(0)
    s_nop 0
    s_add_u32 m0, s64, -768
    v_mfma_f32_32x32x16_bf16 v[96:111], v[176:179], v[32:35], v[96:111]
    buffer_load_dwordx4 v7, s[44:47], s60 offen offset:768 lds
    ds_read_b64_tr_b16 v[64:65], v16 offset:24576
    ds_read_b64_tr_b16 v[66:67], v16 offset:25088
    ds_read_b64_tr_b16 v[68:69], v17 offset:24576
    v_mfma_f32_32x32x16_bf16 v[112:127], v[176:179], v[36:39], v[112:127]
    buffer_load_dwordx4 v8, s[44:47], s60 offen offset:1792 lds
    ds_read_b64_tr_b16 v[70:71], v17 offset:25088
    ds_read_b64_tr_b16 v[72:73], v16 offset:26624
    ds_read_b64_tr_b16 v[74:75], v16 offset:27136
    v_mfma_f32_32x32x16_bf16 v[96:111], v[180:183], v[40:43], v[96:111]
    buffer_load_dwordx4 v9, s[44:47], s60 offen offset:2816 lds
    ds_read_b64_tr_b16 v[76:77], v17 offset:26624
    ds_read_b64_tr_b16 v[78:79], v17 offset:27136
    ds_read_b64_tr_b16 v[80:81], v16 offset:28672
    v_mfma_f32_32x32x16_bf16 v[112:127], v[180:183], v[44:47], v[112:127]
    buffer_load_dwordx4 v10, s[44:47], s60 offen offset:3840 lds
    ds_read_b64_tr_b16 v[82:83], v16 offset:29184
    ds_read_b64_tr_b16 v[84:85], v17 offset:28672
    ds_read_b64_tr_b16 v[86:87], v17 offset:29184
    v_mfma_f32_32x32x16_bf16 v[96:111], v[184:187], v[48:51], v[96:111]
    ds_read_b64_tr_b16 v[88:89], v16 offset:30720
L_sp1:
    s_cbranch_execz L_mha1
    ds_read_b64_tr_b16 v[90:91], v16 offset:31232
    ds_read_b64_tr_b16 v[92:93], v17 offset:30720
    ds_read_b64_tr_b16 v[94:95], v17 offset:31232
    v_mfma_f32_32x32x16_bf16 v[112:127], v[184:187], v[52:55], v[112:127]
    s_add_u32 m0, s74, 8192
    s_add_u32 s83, s82, 344064
    s_waitcnt vmcnt(10)
    ds_read_b128 v[208:211], v11 offset:4096
    ds_read_b128 v[212:215], v12 offset:4096
    ds_read_b128 v[216:219], v13 offset:4096
    ds_read_b128 v[220:223], v14 offset:4096
    v_mfma_f32_32x32x16_bf16 v[96:111], v[188:191], v[56:59], v[96:111]
    buffer_load_dwordx4 v21, s[48:51], s83 offen lds
    s_add_u32 m0, s74, 12288
    s_add_u32 s83, s82, 516096
    v_mfma_f32_32x32x16_bf16 v[112:127], v[188:191], v[60:63], v[112:127]
    buffer_load_dwordx4 v21, s[48:51], s83 offen lds
    s_waitcnt lgkmcnt(0)
    s_nop 0
    s_add_u32 m0, s64, 4096
    s_add_u32 s83, s82, 688128
    v_mfma_f32_32x32x16_bf16 v[96:111], v[192:195], v[64:67], v[96:111]
    buffer_load_dwordx4 v21, s[48:51], s83 offen lds
    s_add_u32 m0, s64, 5120
    s_add_u32 s83, s82, 860160
    ds_read_b64_tr_b16 v[32:33], v16 offset:32768
    ds_read_b64_tr_b16 v[34:35], v16 offset:33280
    ds_read_b64_tr_b16 v[36:37], v17 offset:32768
    v_mfma_f32_32x32x16_bf16 v[112:127], v[192:195], v[68:71], v[112:127]
    buffer_load_dwordx4 v21, s[48:51], s83 offen lds
    s_add_u32 m0, s64, 6144
    s_add_u32 s83, s82, 1032192
    ds_read_b64_tr_b16 v[38:39], v17 offset:33280
    ds_read_b64_tr_b16 v[40:41], v16 offset:34816
    ds_read_b64_tr_b16 v[42:43], v16 offset:35328
L_pad4:
    s_cbranch_execz L_pad20
    s_nop 0
    v_mfma_f32_32x32x16_bf16 v[96:111], v[196:199], v[72:75], v[96:111]
    buffer_load_dwordx4 v21, s[48:51], s83 offen lds
    ds_read_b64_tr_b16 v[44:45], v17 offset:34816
    ds_read_b64_tr_b16 v[46:47], v17 offset:35328
    ds_read_b64_tr_b16 v[48:49], v16 offset:36864
    v_mfma_f32_32x32x16_bf16 v[112:127], v[196:199], v[76:79], v[112:127]
    ds_read_b64_tr_b16 v[50:51], v16 offset:37376
    ds_read_b64_tr_b16 v[52:53], v17 offset:36864
    ds_read_b64_tr_b16 v[54:55], v17 offset:37376
    v_mfma_f32_32x32x16_bf16 v[96:111], v[200:203], v[80:83], v[96:111]
    ds_read_b64_tr_b16 v[56:57], v16 offset:38912
    ds_read_b64_tr_b16 v[58:59], v16 offset:39424
    ds_read_b64_tr_b16 v[60:61], v17 offset:38912
    ds_read_b64_tr_b16 v[62:63], v17 offset:39424
    v_mfma_f32_32x32x16_bf16 v[112:127], v[200:203], v[84:87], v[112:127]
    s_waitcnt vmcnt(11)
    ds_read_b128 v[224:227], v11 offset:8192
    ds_read_b128 v[228:231], v12 offset:8192
    ds_read_b128 v[232:235], v13 offset:8192
    ds_read_b128 v[236:239], v14 offset:8192
    v_mfma_f32_32x32x16_bf16 v[96:111], v[204:207], v[88:91], v[96:111]
    v_mfma_f32_32x32x16_bf16 v[112:127], v[204:207], v[92:95], v[112:127]
    s_waitcnt lgkmcnt(0)
    v_mfma_f32_32x32x16_bf16 v[96:111], v[208:211], v[32:35], v[96:111]
    ds_read_b64_tr_b16 v[64:65], v16 offset:40960
    ds_read_b64_tr_b16 v[66:67], v16 offset:41472
    ds_read_b64_tr_b16 v[68:69], v17 offset:40960
    v_mfma_f32_32x32x16_bf16 v[112:127], v[208:211], v[36:39], v[112:127]
    ds_read_b64_tr_b16 v[70:71], v17 offset:41472
    ds_read_b64_tr_b16 v[72:73], v16 offset:43008
    ds_read_b64_tr_b16 v[74:75], v16 offset:43520
    v_mfma_f32_32x32x16_bf16 v[96:111], v[212:215], v[40:43], v[96:111]
    ds_read_b64_tr_b16 v[76:77], v17 offset:43008
    ds_read_b64_tr_b16 v[78:79], v17 offset:43520
    ds_read_b64_tr_b16 v[80:81], v16 offset:45056
    v_mfma_f32_32x32x16_bf16 v[112:127], v[212:215], v[44:47], v[112:127]
    ds_read_b64_tr_b16 v[82:83], v16 offset:45568
    ds_read_b64_tr_b16 v[84:85], v17 offset:45056
    ds_read_b64_tr_b16 v[86:87], v17 offset:45568
    v_mfma_f32_32x32x16_bf16 v[96:111], v[216:219], v[48:51], v[96:111]
    ds_read_b64_tr_b16 v[88:89], v16 offset:47104
    ds_read_b64_tr_b16 v[90:91], v16 offset:47616
    ds_read_b64_tr_b16 v[92:93], v17 offset:47104
    ds_read_b64_tr_b16 v[94:95], v17 offset:47616
    v_mfma_f32_32x32x16_bf16 v[112:127], v[216:219], v[52:55], v[112:127]
    s_waitcnt vmcnt(5)
    ds_read_b128 v[240:243], v11 offset:0
    ds_read_b128 v[244:247], v12 offset:0
    ds_read_b128 v[248:251], v13 offset:0
    ds_read_b128 v[252:255], v14 offset:0
    v_mfma_f32_32x32x16_bf16 v[96:111], v[220:223], v[56:59], v[96:111]
    v_mfma_f32_32x32x16_bf16 v[112:127], v[220:223], v[60:63], v[112:127]
    s_waitcnt lgkmcnt(4)
    v_mfma_f32_32x32x16_bf16 v[96:111], v[224:227], v[64:67], v[96:111]
    ds_read_b64_tr_b16 v[32:33], v16 offset:49152
    ds_read_b64_tr_b16 v[34:35], v16 offset:49664
    ds_read_b64_tr_b16 v[36:37], v17 offset:49152
    v_mfma_f32_32x32x16_bf16 v[112:127], v[224:227], v[68:71], v[112:127]
    ds_read_b64_tr_b16 v[38:39], v17 offset:49664
    ds_read_b64_tr_b16 v[40:41], v16 offset:51200
    ds_read_b64_tr_b16 v[42:43], v16 offset:51712
    v_mfma_f32_32x32x16_bf16 v[96:111], v[228:231], v[72:75], v[96:111]
    ds_read_b64_tr_b16 v[44:45], v17 offset:51200
    ds_read_b64_tr_b16 v[46:47], v17 offset:51712
    ds_read_b64_tr_b16 v[48:49], v16 offset:53248
    v_mfma_f32_32x32x16_bf16 v[112:127], v[228:231], v[76:79], v[112:127]
    ds_read_b64_tr_b16 v[50:51], v16 offset:53760
    ds_read_b64_tr_b16 v[52:53], v17 offset:53248
    ds_read_b64_tr_b16 v[54:55], v17 offset:53760
    v_mfma_f32_32x32x16_bf16 v[96:111], v[232:235], v[80:83], v[96:111]
    ds_read_b64_tr_b16 v[56:57], v16 offset:55296
    ds_read_b64_tr_b16 v[58:59], v16 offset:55808
    ds_read_b64_tr_b16 v[60:61], v17 offset:55296
    ds_read_b64_tr_b16 v[62:63], v17 offset:55808
    v_mfma_f32_32x32x16_bf16 v[112:127], v[232:235], v[84:87], v[112:127]
    ds_read_b32 v31, v3 offset:16
    v_mfma_f32_32x32x16_bf16 v[96:111], v[236:239], v[88:91], v[96:111]
    s_add_u32 s68, s67, s69
    s_add_u32 s60, s67, 131072
    s_add_u32 s63, s68, 131072
    v_mfma_f32_32x32x16_bf16 v[112:127], v[236:239], v[92:95], v[112:127]
    s_waitcnt lgkmcnt(0)
    v_mfma_f32_32x32x16_bf16 v[96:111], v[240:243], v[32:35], v[96:111]
L_ec_v6:
    s_waitcnt lgkmcnt(0)
    v_cmp_gt_u32 vcc, 1, v31
    ds_read_b32 v31, v3 offset:16
    s_cbranch_vccnz L_ec_v6
    v_mfma_f32_32x32x16_bf16 v[96:111], v[244:247], v[40:43], v[96:111]
    v_mfma_f32_32x32x16_bf16 v[96:111], v[248:251], v[48:51], v[96:111]
    v_mfma_f32_32x32x16_bf16 v[96:111], v[252:255], v[56:59], v[96:111]
    v_mfma_f32_32x32x16_bf16 v[112:127], v[240:243], v[36:39], v[112:127]
    s_nop 4
    v_mfma_f32_32x32x16_bf16 v[112:127], v[244:247], v[44:47], v[112:127]
    s_nop 3
    v_mfma_f32_32x32x16_bf16 v[112:127], v[248:251], v[52:55], v[112:127]
    v_cvt_pk_bf16_f32 v128, v96, v97
    v_cvt_pk_bf16_f32 v129, v98, v99
    v_cvt_pk_bf16_f32 v130, v100, v101
    v_cvt_pk_bf16_f32 v131, v102, v103
    buffer_store_dwordx4 v[128:131], v20, s[40:43], s67 offen sc1
    v_mfma_f32_32x32x16_bf16 v[112:127], v[252:255], v[60:63], v[112:127]
L_gemm_done:
L_sp2:
    s_cbranch_execz L_mha1
L_pad5:
    s_cbranch_execz L_pad_ret
    v_cvt_pk_bf16_f32 v132, v104, v105
    v_cvt_pk_bf16_f32 v133, v106, v107
    v_cvt_pk_bf16_f32 v134, v108, v109
    v_cvt_pk_bf16_f32 v135, v110, v111
    buffer_store_dwordx4 v[132:135], v20, s[40:43], s68 offen sc1
    s_nop 6
    v_cvt_pk_bf16_f32 v136, v112, v113
    v_cvt_pk_bf16_f32 v137, v114, v115
    v_cvt_pk_bf16_f32 v138, v116, v117
    v_cvt_pk_bf16_f32 v139, v118, v119
    buffer_store_dwordx4 v[136:139], v20, s[40:43], s60 offen sc1
    v_cvt_pk_bf16_f32 v140, v120, v121
    v_cvt_pk_bf16_f32 v141, v122, v123
    v_cvt_pk_bf16_f32 v142, v124, v125
    v_cvt_pk_bf16_f32 v143, v126, v127
    buffer_store_dwordx4 v[140:143], v20, s[40:43], s63 offen sc1
    s_waitcnt vmcnt(4)
    v_mov_b32 v1, 7
    ds_write_b32 v2, v1
L_nokv:
L_lw_2:
    ds_read_b32 v1, v3
    s_waitcnt lgkmcnt(0)
    v_cmp_gt_u32_e64 vcc, 7, v1
    s_cbranch_vccnz L_lw_2
    ds_read_b64_tr_b16 v[80:81], v15 offset:0
    ds_read_b64_tr_b16 v[82:83], v15 offset:256
    ds_read_b64_tr_b16 v[84:85], v15 offset:1024
    ds_read_b64_tr_b16 v[86:87], v15 offset:1280
    ds_read_b64_tr_b16 v[88:89], v15 offset:2048
    ds_read_b64_tr_b16 v[90:91], v15 offset:2304
    ds_read_b64_tr_b16 v[92:93], v15 offset:3072
    ds_read_b64_tr_b16 v[94:95], v15 offset:3328
    ds_read_b64_tr_b16 v[112:113], v15 offset:4096
    ds_read_b64_tr_b16 v[114:115], v15 offset:4352
    ds_read_b64_tr_b16 v[116:117], v15 offset:5120
    ds_read_b64_tr_b16 v[118:119], v15 offset:5376
    v_subrev_u32 v10, 49152, v19
    s_mov_b64 s[80:81], -1
    s_add_u32 s65, s31, 1
    s_and_b32 s65, s65, 3
    s_sub_u32 s65, s65, s31
    s_mul_i32 s65, s65, 12288
    v_add_u32 v11, s65, v19
    v_subrev_u32 v7, 49152, v11
    s_add_u32 s65, s31, 2
    s_and_b32 s65, s65, 3
    s_sub_u32 s65, s65, s31
    s_mul_i32 s65, s65, 12288
    s_waitcnt lgkmcnt(10)
    v_mfma_f32_32x32x16_bf16 v[96:111], v[80:83], v[144:147], 0
    ds_read_b64_tr_b16 v[120:121], v15 offset:6144
    ds_read_b64_tr_b16 v[122:123], v15 offset:6400
    v_add_u32 v12, s65, v19
    v_subrev_u32 v8, 45056, v12
    s_add_u32 s65, s31, 3
    s_and_b32 s65, s65, 3
    s_waitcnt lgkmcnt(10)
    v_mfma_f32_32x32x16_bf16 v[96:111], v[84:87], v[148:151], v[96:111]
    ds_read_b64_tr_b16 v[124:125], v15 offset:7168
    ds_read_b64_tr_b16 v[126:127], v15 offset:7424
    s_sub_u32 s65, s65, s31
    s_mul_i32 s65, s65, 12288
    v_add_u32_e64 v13, s65, v19
    v_subrev_u32 v9, 40960, v13
    s_waitcnt lgkmcnt(10)
    v_mfma_f32_32x32x16_bf16 v[96:111], v[88:91], v[152:155], v[96:111]
    ds_read_b64_tr_b16 v[80:81], v15 offset:8192
    ds_read_b64_tr_b16 v[82:83], v15 offset:8448
    s_waitcnt lgkmcnt(10)
    v_mfma_f32_32x32x16_bf16 v[96:111], v[92:95], v[156:159], v[96:111]
    ds_read_b64_tr_b16 v[84:85], v15 offset:9216
    ds_read_b64_tr_b16 v[86:87], v15 offset:9472
    s_waitcnt lgkmcnt(10)
    v_mfma_f32_32x32x16_bf16 v[96:111], v[112:115], v[160:163], v[96:111]
    ds_read_b64_tr_b16 v[88:89], v15 offset:10240
    ds_read_b64_tr_b16 v[90:91], v15 offset:10496
    s_waitcnt lgkmcnt(10)
    v_mfma_f32_32x32x16_bf16 v[96:111], v[116:119], v[164:167], v[96:111]
    ds_read_b64_tr_b16 v[92:93], v15 offset:11264
    ds_read_b64_tr_b16 v[94:95], v15 offset:11520
    s_waitcnt lgkmcnt(10)
    v_mfma_f32_32x32x16_bf16 v[96:111], v[120:123], v[168:171], v[96:111]
    ds_read_b64_tr_b16 v[112:113], v15 offset:12288
    ds_read_b64_tr_b16 v[114:115], v15 offset:12544
    v_mov_b64 v[160:161], 0
    v_mov_b64 v[162:163], 0
    s_waitcnt lgkmcnt(10)
    v_mfma_f32_32x32x16_bf16 v[96:111], v[124:127], v[172:175], v[96:111]
    ds_read_b64_tr_b16 v[116:117], v15 offset:13312
    ds_read_b64_tr_b16 v[118:119], v15 offset:13568
    v_mov_b64 v[164:165], 0
    v_mov_b64 v[166:167], 0
    s_waitcnt lgkmcnt(10)
    v_mfma_f32_32x32x16_bf16 v[96:111], v[80:83], v[176:179], v[96:111]
    ds_read_b64_tr_b16 v[120:121], v15 offset:14336
    ds_read_b64_tr_b16 v[122:123], v15 offset:14592
    v_mov_b64 v[168:169], 0
    v_mov_b64 v[170:171], 0
    s_waitcnt lgkmcnt(10)
    v_mfma_f32_32x32x16_bf16 v[96:111], v[84:87], v[180:183], v[96:111]
    ds_read_b64_tr_b16 v[124:125], v15 offset:15360
    ds_read_b64_tr_b16 v[126:127], v15 offset:15616
    v_mov_b64 v[172:173], 0
    v_mov_b64_e64 v[174:175], 0
    s_waitcnt lgkmcnt(10)
    v_mfma_f32_32x32x16_bf16 v[96:111], v[88:91], v[184:187], v[96:111]
    ds_read_b64_tr_b16 v[80:81], v22 offset:0
    ds_read_b64_tr_b16 v[82:83], v22 offset:256
    v_mov_b64 v[176:177], 0
    v_mov_b64_e64 v[178:179], 0
    s_waitcnt lgkmcnt(10)
    v_mfma_f32_32x32x16_bf16 v[96:111], v[92:95], v[188:191], v[96:111]
    ds_read_b64_tr_b16 v[84:85], v22 offset:12288
    ds_read_b64_tr_b16 v[86:87], v22 offset:12544
    v_mov_b64 v[180:181], 0
    v_mov_b64_e64 v[182:183], 0
    s_waitcnt lgkmcnt(10)
    v_mfma_f32_32x32x16_bf16 v[96:111], v[112:115], v[192:195], v[96:111]
    ds_read_b64_tr_b16 v[88:89], v22 offset:24576
    ds_read_b64_tr_b16 v[90:91], v22 offset:24832
    v_mov_b64 v[184:185], 0
    v_mov_b64 v[186:187], 0
    s_waitcnt lgkmcnt(10)
    v_mfma_f32_32x32x16_bf16 v[96:111], v[116:119], v[196:199], v[96:111]
    ds_read_b64_tr_b16 v[92:93], v22 offset:36864
    ds_read_b64_tr_b16 v[94:95], v22 offset:37120
    v_mov_b64 v[188:189], 0
    v_mov_b64 v[190:191], 0
    s_waitcnt lgkmcnt(10)
    v_mfma_f32_32x32x16_bf16 v[96:111], v[120:123], v[200:203], v[96:111]
    ds_read_b64_tr_b16 v[112:113], v22 offset:1024
    ds_read_b64_tr_b16 v[114:115], v22 offset:1280
    v_mov_b64 v[192:193], 0
    v_mov_b64 v[194:195], 0
    v_mov_b32 v1, 1
    v_mov_b32 v31, 0
    s_waitcnt vmcnt(0)
    s_mov_b64 exec, 1
    ds_add_rtn_u32 v20, v31, v1 offset:32
    s_mov_b64 exec, -1
    s_waitcnt lgkmcnt(11)
    v_mfma_f32_32x32x16_bf16 v[96:111], v[124:127], v[204:207], v[96:111]
    ds_read_b64_tr_b16 v[116:117], v22 offset:13312
    ds_read_b64_tr_b16 v[118:119], v22 offset:13568
    v_mov_b64 v[196:197], 0
    v_mov_b64 v[198:199], 0
    s_waitcnt lgkmcnt(2)
    v_readfirstlane_b32 s66, v20
    s_cmp_lg_u32 s66, 3
    s_cbranch_scc1 L_nopub
    v_mov_b32 v1, s37
    v_mov_b32 v31, 0
    s_mov_b64 exec, 1
    buffer_store_dword v1, v31, s[40:43], s70 offen sc1
    s_mov_b64 exec, -1
L_nopub:
    s_waitcnt lgkmcnt(11)
    v_mfma_f32_32x32x16_bf16 v[96:111], v[80:83], v[208:211], v[96:111]
    ds_read_b64_tr_b16 v[120:121], v22 offset:25600
    ds_read_b64_tr_b16 v[122:123], v22 offset:25856
    v_mov_b64 v[200:201], 0
    v_mov_b64 v[202:203], 0
    s_waitcnt lgkmcnt(11)
    v_mfma_f32_32x32x16_bf16 v[96:111], v[84:87], v[212:215], v[96:111]
    ds_read_b64_tr_b16 v[124:125], v22 offset:37888
    ds_read_b64_tr_b16 v[126:127], v22 offset:38144
    v_mov_b64 v[204:205], 0
    v_mov_b64_e64 v[206:207], 0
    s_waitcnt lgkmcnt(11)
    v_mfma_f32_32x32x16_bf16 v[96:111], v[88:91], v[216:219], v[96:111]
    ds_read_b64_tr_b16 v[80:81], v22 offset:2048
L_pad6:
    s_cbranch_execz L_pad_ret
    ds_read_b64_tr_b16 v[82:83], v22 offset:2304
    v_mov_b64 v[208:209], 0
    v_mov_b64 v[210:211], 0
    s_waitcnt lgkmcnt(11)
    v_mfma_f32_32x32x16_bf16 v[96:111], v[92:95], v[220:223], v[96:111]
    ds_read_b64_tr_b16 v[84:85], v22 offset:14336
    ds_read_b64_tr_b16 v[86:87], v22 offset:14592
    v_mov_b64 v[212:213], 0
    v_mov_b64_e64 v[214:215], 0
    s_waitcnt lgkmcnt(10)
    v_mfma_f32_32x32x16_bf16 v[96:111], v[112:115], v[224:227], v[96:111]
    ds_read_b64_tr_b16 v[88:89], v22 offset:26624
    ds_read_b64_tr_b16 v[90:91], v22 offset:26880
    v_mov_b64 v[216:217], 0
    v_mov_b64_e64 v[218:219], 0
    s_waitcnt lgkmcnt(10)
    v_mfma_f32_32x32x16_bf16 v[96:111], v[116:119], v[228:231], v[96:111]
    ds_read_b64_tr_b16 v[92:93], v22 offset:38912
    ds_read_b64_tr_b16 v[94:95], v22 offset:39168
    v_mov_b64 v[220:221], 0
    v_mov_b64_e64 v[222:223], 0
    s_waitcnt lgkmcnt(10)
    v_mfma_f32_32x32x16_bf16 v[96:111], v[120:123], v[232:235], v[96:111]
    s_waitcnt lgkmcnt(8)
    v_mfma_f32_32x32x16_bf16 v[96:111], v[124:127], v[236:239], v[96:111]
    s_waitcnt lgkmcnt(6)
    v_mfma_f32_32x32x16_bf16 v[96:111], v[80:83], v[240:243], v[96:111]
    s_waitcnt lgkmcnt(4)
    v_mfma_f32_32x32x16_bf16 v[96:111], v[84:87], v[244:247], v[96:111]
    s_waitcnt lgkmcnt(2)
    v_mfma_f32_32x32x16_bf16 v[96:111], v[88:91], v[248:251], v[96:111]
    s_waitcnt lgkmcnt(0)
    v_mfma_f32_32x32x16_bf16 v[96:111], v[92:95], v[252:255], v[96:111]
    s_nop 11
    v_mul_f32 v96, v24, v96
    v_mul_f32 v97, v24, v97
    v_mul_f32 v98, v24, v98
    v_mul_f32 v99, v24, v99
    v_mul_f32 v100, v26, v100
    v_mul_f32 v101, v26, v101
    v_mul_f32 v102, v26, v102
    v_mul_f32 v103, v26, v103
    v_mul_f32 v104, v26, v104
    v_mul_f32 v105, v26, v105
    v_mul_f32 v106, v26, v106
    v_mul_f32 v107, v26, v107
    v_mul_f32 v108, v25, v108
    v_mul_f32 v109, v25, v109
    v_mul_f32 v110, v25, v110
    v_mul_f32 v111, v25, v111
    v_cvt_pk_bf16_f32 v248, v96, v97
    v_cvt_pk_bf16_f32 v249, v98, v99
    v_cvt_pk_bf16_f32 v250, v100, v101
    v_cvt_pk_bf16_f32 v251, v102, v103
    v_cvt_pk_bf16_f32 v252, v104, v105
    v_cvt_pk_bf16_f32 v253, v106, v107
    v_cvt_pk_bf16_f32 v254, v108, v109
    v_cvt_pk_bf16_f32 v255, v110, v111
    ds_write_b128 v19, v[248:251]
    ds_write_b128 v19, v[252:255] offset:1024
    v_mov_b32_e64 v1, 8
    ds_write_b32 v2, v1
L_lw_3:
    ds_read_b32 v1, v3
    s_waitcnt lgkmcnt(0)
    v_cmp_gt_u32_e64 vcc, 8, v1
    s_cbranch_vccnz L_lw_3
    ds_read_b128 v[224:227], v11
    ds_read_b128 v[228:231], v11 offset:1024
    ds_read_b128 v[232:235], v12
    ds_read_b128 v[236:239], v12 offset:1024
    ds_read_b128 v[240:243], v13
    ds_read_b128 v[244:247], v13 offset:1024
    s_mov_b64 exec, 0
    s_bitcmp1_b32 s31, 0
    s_cbranch_scc1 L_pg1
    s_branch L_pg0
L_pg_ret:
    s_mov_b64 exec, -1
L_pl_4:
    buffer_load_dword v31, v23, s[40:43], 0 offen sc1
L_pm_6:
    s_waitcnt vmcnt(0)
    v_cmp_ne_u32_e64 vcc, s37, v31
    s_cbranch_vccz L_pd_5
    s_sub_u32 s56, s56, 1
    s_cbranch_scc0 L_pl_4
    s_mov_b32 s56, 0
L_pd_5:
    buffer_load_dwordx4 v[64:67], v27, s[40:43], s71 offen offset:0 sc1
    buffer_load_dwordx4 v[68:71], v28, s[40:43], s71 offen offset:0 sc1
    buffer_load_dwordx4 v[32:35], v29, s[40:43], s72 offen offset:0 sc1
    buffer_load_dwordx4 v[36:39], v29, s[40:43], s72 offen offset:128 sc1
    buffer_load_dwordx4 v[72:75], v27, s[40:43], s71 offen offset:512 sc1
    buffer_load_dwordx4 v[76:79], v28, s[40:43], s71 offen offset:512 sc1
    buffer_load_dwordx4 v[40:43], v29, s[40:43], s72 offen offset:256 sc1
    buffer_load_dwordx4 v[44:47], v29, s[40:43], s72 offen offset:384 sc1
L_kv_done:
    s_lshr_b32 s65, s38, 3
    s_add_u32 s66, s38, 3
    s_lshr_b32 s66, s66, 3
    s_sub_u32 s66, s66, s65
    s_lshl_b32 s66, s66, 1
    s_lshl2_add_u32 s67, s34, s31
    s_lshr_b32 s68, s67, 1
    s_mul_i32 s68, s68, 12
    s_add_u32 s67, s67, s68
    s_lshl1_add_u32 s65, s65, s67
    s_lshl_b32 s65, s65, 7
    s_add_u32 s65, s65, 397312
    v_and_b32 v23, 1, v0
    v_mul_u32_u24 v23, s66, v23
    v_and_b32 v31, 2, v0
    v_lshl_add_u32 v23, v31, 8, v23
    v_lshl_add_u32 v23, v23, 7, s65
    s_add_u32 s63, s71, 4096
    s_bitcmp1_b32 s36, 0
    s_cselect_b32 s4, 0, -1
    s_mov_b32 s5, -1
    s_mov_b32 s6, -1
    s_cselect_b32 s7, -1, 0
    s_add_u32 s8, s85, 8
    s_cmp_eq_u32 s4, 0
    s_cselect_b32 s8, s8, s86
    s_and_b64 s[10:11], s[4:5], s[6:7]
    s_mov_b32 s9, 1090519040
    s_mov_b32 s73, 0
    s_waitcnt vmcnt(4) lgkmcnt(0)
    v_mfma_f32_32x32x16_bf16 v[96:111], v[64:67], v[224:227], 0
    v_mfma_f32_32x32x16_bf16 v[96:111], v[68:71], v[228:231], v[96:111]
    s_setprio 1
    s_nop 9
L_pad7:
    s_cbranch_execz L_pad_ret
L_att:
    v_mfma_f32_32x32x16_bf16 v[112:127], v[64:67], v[232:235], 0
    v_exp_f32 v96, v96
    v_exp_f32 v97, v97
    v_exp_f32 v98, v98
    v_exp_f32 v99, v99
    v_mfma_f32_32x32x16_bf16 v[112:127], v[68:71], v[236:239], v[112:127]
    v_exp_f32 v100, v100
    v_exp_f32 v101, v101
    v_exp_f32 v102, v102
    v_exp_f32 v103, v103
    buffer_load_dwordx4 v[80:83], v27, s[40:43], s71 offen offset:1024 sc1
    buffer_load_dwordx4 v[84:87], v28, s[40:43], s71 offen offset:1024 sc1
    buffer_load_dwordx4 v[48:51], v29, s[40:43], s72 offen offset:512 sc1
    buffer_load_dwordx4 v[52:55], v29, s[40:43], s72 offen offset:640 sc1
    v_exp_f32 v104, v104
    v_exp_f32 v105, v105
    v_exp_f32 v106, v106
    v_exp_f32 v107, v107
    v_exp_f32 v108, v108
    v_exp_f32 v109, v109
    v_exp_f32 v110, v110
    v_exp_f32 v111, v111
    v_mfma_f32_32x32x16_bf16 v[128:143], v[64:67], v[240:243], 0
    v_exp_f32 v112, v112
    v_exp_f32 v113, v113
    v_exp_f32 v114, v114
    v_exp_f32 v115, v115
    v_mfma_f32_32x32x16_bf16 v[128:143], v[68:71], v[244:247], v[128:143]
    v_exp_f32 v116, v116
    v_exp_f32 v117, v117
    v_exp_f32 v118, v118
    v_exp_f32 v119, v119
    v_smfmac_f32_32x32x32_bf16 v[160:175], v[32:35], v[96:103], v30
    buffer_load_dwordx4 v[88:91], v27, s[40:43], s71 offen offset:1536 sc1
    buffer_load_dwordx4 v[92:95], v28, s[40:43], s71 offen offset:1536 sc1
    buffer_load_dwordx4 v[56:59], v29, s[40:43], s72 offen offset:768 sc1
    buffer_load_dwordx4 v[60:63], v29, s[40:43], s72 offen offset:896 sc1
    v_exp_f32 v120, v120
    v_exp_f32 v121, v121
    v_exp_f32 v122, v122
    v_exp_f32 v123, v123
    v_smfmac_f32_32x32x32_bf16 v[160:175], v[36:39], v[104:111], v30
    v_exp_f32 v124, v124
    v_exp_f32 v125, v125
    v_exp_f32 v126, v126
    v_exp_f32 v127, v127
    v_mfma_f32_32x32x16_bf16 v[144:159], v[64:67], v[248:251], 0
    v_exp_f32 v128, v128
    v_exp_f32 v129, v129
    v_exp_f32 v130, v130
    v_exp_f32 v131, v131
    v_mfma_f32_32x32x16_bf16 v[144:159], v[68:71], v[252:255], v[144:159]
    v_exp_f32 v132, v132
    v_exp_f32 v133, v133
    v_exp_f32 v134, v134
    v_exp_f32 v135, v135
    v_smfmac_f32_32x32x32_bf16 v[176:191], v[32:35], v[112:119], v30
    v_exp_f32 v136, v136
    v_exp_f32 v137, v137
    v_exp_f32 v138, v138
    v_exp_f32 v139, v139
    v_smfmac_f32_32x32x32_bf16 v[176:191], v[36:39], v[120:127], v30
    s_waitcnt vmcnt(8)
    v_exp_f32 v140, v140
    v_exp_f32 v141, v141
    v_exp_f32 v142, v142
    v_exp_f32 v143, v143
    v_mfma_f32_32x32x16_bf16 v[96:111], v[72:75], v[224:227], 0
    v_exp_f32 v144, v144
    v_exp_f32 v145, v145
    v_exp_f32 v146, v146
    v_exp_f32_e64 v147, v147
    v_mfma_f32_32x32x16_bf16 v[96:111], v[76:79], v[228:231], v[96:111]
    v_exp_f32 v148, v148
    v_exp_f32 v149, v149
    v_exp_f32 v150, v150
    v_exp_f32 v151, v151
    v_smfmac_f32_32x32x32_bf16 v[192:207], v[32:35], v[128:135], v30
    v_exp_f32 v152, v152
    v_exp_f32 v153, v153
    v_exp_f32 v154, v154
    v_exp_f32 v155, v155
    v_smfmac_f32_32x32x32_bf16 v[192:207], v[36:39], v[136:143], v30
    v_exp_f32 v156, v156
    v_exp_f32 v157, v157
    v_exp_f32 v158, v158
    v_exp_f32 v159, v159
    v_mfma_f32_32x32x16_bf16 v[112:127], v[72:75], v[232:235], 0
    v_exp_f32 v96, v96
    v_exp_f32 v97, v97
    v_exp_f32 v98, v98
    v_exp_f32 v99, v99
    v_mfma_f32_32x32x16_bf16 v[112:127], v[76:79], v[236:239], v[112:127]
    v_exp_f32 v100, v100
    v_exp_f32 v101, v101
    v_exp_f32 v102, v102
    v_exp_f32 v103, v103
    v_smfmac_f32_32x32x32_bf16 v[208:223], v[32:35], v[144:151], v30
    v_exp_f32 v104, v104
    v_exp_f32 v105, v105
    v_exp_f32 v106, v106
    v_exp_f32 v107, v107
    v_smfmac_f32_32x32x32_bf16 v[208:223], v[36:39], v[152:159], v30
    v_exp_f32 v108, v108
    v_exp_f32 v109, v109
    v_exp_f32 v110, v110
    v_exp_f32 v111, v111
    v_mfma_f32_32x32x16_bf16 v[128:143], v[72:75], v[240:243], 0
    v_exp_f32 v112, v112
    v_exp_f32 v113, v113
    v_exp_f32 v114, v114
    v_exp_f32 v115, v115
    v_mfma_f32_32x32x16_bf16 v[128:143], v[76:79], v[244:247], v[128:143]
    v_exp_f32 v116, v116
    v_exp_f32 v117, v117
    v_exp_f32 v118, v118
    v_exp_f32 v119, v119
    v_smfmac_f32_32x32x32_bf16 v[160:175], v[40:43], v[96:103], v30
    buffer_load_dwordx4 v[64:67], v27, s[40:43], s71 offen offset:2048 sc1
    buffer_load_dwordx4 v[68:71], v28, s[40:43], s71 offen offset:2048 sc1
    buffer_load_dwordx4 v[32:35], v29, s[40:43], s72 offen offset:1024 sc1
    buffer_load_dwordx4 v[36:39], v29, s[40:43], s72 offen offset:1152 sc1
    v_exp_f32 v120, v120
    v_exp_f32 v121, v121
    v_exp_f32 v122, v122
    v_exp_f32 v123, v123
    v_smfmac_f32_32x32x32_bf16 v[160:175], v[44:47], v[104:111], v30
    v_exp_f32 v124, v124
    v_exp_f32 v125, v125
    v_exp_f32 v126, v126
    v_exp_f32 v127, v127
    v_mfma_f32_32x32x16_bf16 v[144:159], v[72:75], v[248:251], 0
    v_exp_f32 v128, v128
    v_exp_f32 v129, v129
    v_exp_f32 v130, v130
    v_exp_f32 v131, v131
    v_mfma_f32_32x32x16_bf16 v[144:159], v[76:79], v[252:255], v[144:159]
    v_exp_f32 v132, v132
    v_exp_f32 v133, v133
    v_exp_f32 v134, v134
    v_exp_f32 v135, v135
    v_smfmac_f32_32x32x32_bf16 v[176:191], v[40:43], v[112:119], v30
    v_exp_f32 v136, v136
    v_exp_f32 v137, v137
    v_exp_f32 v138, v138
    v_exp_f32 v139, v139
    v_smfmac_f32_32x32x32_bf16 v[176:191], v[44:47], v[120:127], v30
    s_waitcnt vmcnt(8)
    v_exp_f32 v140, v140
    v_exp_f32 v141, v141
    v_exp_f32 v142, v142
    v_exp_f32 v143, v143
    v_mfma_f32_32x32x16_bf16 v[96:111], v[80:83], v[224:227], 0
    v_exp_f32 v144, v144
    v_exp_f32 v145, v145
    v_exp_f32 v146, v146
    v_exp_f32 v147, v147
    v_mfma_f32_32x32x16_bf16 v[96:111], v[84:87], v[228:231], v[96:111]
    v_exp_f32 v148, v148
    v_exp_f32 v149, v149
    v_exp_f32 v150, v150
    v_exp_f32_e64 v151, v151
    v_smfmac_f32_32x32x32_bf16 v[192:207], v[40:43], v[128:135], v30
    v_exp_f32 v152, v152
    v_exp_f32 v153, v153
    v_exp_f32 v154, v154
    v_exp_f32 v155, v155
    v_smfmac_f32_32x32x32_bf16 v[192:207], v[44:47], v[136:143], v30
    v_exp_f32 v156, v156
    v_exp_f32 v157, v157
    v_exp_f32 v158, v158
    v_exp_f32 v159, v159
    v_mfma_f32_32x32x16_bf16 v[112:127], v[80:83], v[232:235], 0
    v_exp_f32 v96, v96
    v_exp_f32 v97, v97
    v_exp_f32 v98, v98
    v_exp_f32 v99, v99
    v_mfma_f32_32x32x16_bf16 v[112:127], v[84:87], v[236:239], v[112:127]
    v_exp_f32 v100, v100
    v_exp_f32 v101, v101
    v_exp_f32 v102, v102
    v_exp_f32 v103, v103
    v_smfmac_f32_32x32x32_bf16 v[208:223], v[40:43], v[144:151], v30
    v_exp_f32 v104, v104
    v_exp_f32 v105, v105
    v_exp_f32 v106, v106
    v_exp_f32 v107, v107
    v_smfmac_f32_32x32x32_bf16 v[208:223], v[44:47], v[152:159], v30
    v_exp_f32 v108, v108
    v_exp_f32 v109, v109
    v_exp_f32 v110, v110
    v_exp_f32 v111, v111
    v_mfma_f32_32x32x16_bf16 v[128:143], v[80:83], v[240:243], 0
    v_exp_f32 v112, v112
    v_exp_f32 v113, v113
    v_exp_f32 v114, v114
    v_exp_f32 v115, v115
    v_mfma_f32_32x32x16_bf16 v[128:143], v[84:87], v[244:247], v[128:143]
    v_exp_f32 v116, v116
    v_exp_f32 v117, v117
    v_exp_f32 v118, v118
    v_exp_f32 v119, v119
    v_smfmac_f32_32x32x32_bf16 v[160:175], v[48:51], v[96:103], v30
    buffer_load_dwordx4 v[72:75], v27, s[40:43], s71 offen offset:2560 sc1
    buffer_load_dwordx4 v[76:79], v28, s[40:43], s71 offen offset:2560 sc1
    buffer_load_dwordx4 v[40:43], v29, s[40:43], s72 offen offset:1280 sc1
    buffer_load_dwordx4 v[44:47], v29, s[40:43], s72 offen offset:1408 sc1
    v_exp_f32 v120, v120
    v_exp_f32 v121, v121
    v_exp_f32 v122, v122
    v_exp_f32 v123, v123
    v_smfmac_f32_32x32x32_bf16 v[160:175], v[52:55], v[104:111], v30
    v_exp_f32 v124, v124
    v_exp_f32 v125, v125
    v_exp_f32 v126, v126
    v_exp_f32 v127, v127
    v_mfma_f32_32x32x16_bf16 v[144:159], v[80:83], v[248:251], 0
    v_exp_f32 v128, v128
    v_exp_f32 v129, v129
    v_exp_f32 v130, v130
    v_exp_f32 v131, v131
    v_mfma_f32_32x32x16_bf16 v[144:159], v[84:87], v[252:255], v[144:159]
    v_exp_f32 v132, v132
    v_exp_f32 v133, v133
    v_exp_f32 v134, v134
    v_exp_f32 v135, v135
    v_smfmac_f32_32x32x32_bf16 v[176:191], v[48:51], v[112:119], v30
    v_exp_f32 v136, v136
    v_exp_f32 v137, v137
    v_exp_f32 v138, v138
    v_exp_f32 v139, v139
    v_smfmac_f32_32x32x32_bf16 v[176:191], v[52:55], v[120:127], v30
    s_waitcnt vmcnt(8)
    v_exp_f32 v140, v140
    v_exp_f32 v141, v141
    v_exp_f32 v142, v142
    v_exp_f32 v143, v143
    v_mfma_f32_32x32x16_bf16 v[96:111], v[88:91], v[224:227], 0
    v_exp_f32 v144, v144
    v_exp_f32 v145, v145
    v_exp_f32 v146, v146
L_pad8:
    s_cbranch_execz L_pad_ret
    v_exp_f32 v147, v147
    v_mfma_f32_32x32x16_bf16 v[96:111], v[92:95], v[228:231], v[96:111]
    v_exp_f32 v148, v148
    v_exp_f32 v149, v149
    v_exp_f32 v150, v150
    v_exp_f32 v151, v151
    v_smfmac_f32_32x32x32_bf16 v[192:207], v[48:51], v[128:135], v30
L_pg0:
    s_cbranch_execz L_pg_ret
    v_exp_f32 v152, v152
    v_exp_f32 v153, v153
    v_exp_f32 v154, v154
    v_exp_f32 v155, v155
    v_smfmac_f32_32x32x32_bf16 v[192:207], v[52:55], v[136:143], v30
    v_exp_f32 v156, v156
    v_exp_f32 v157, v157
    v_exp_f32 v158, v158
    v_exp_f32_e64 v159, v159
    v_mfma_f32_32x32x16_bf16 v[112:127], v[88:91], v[232:235], 0
    v_exp_f32 v96, v96
    v_exp_f32 v97, v97
    v_exp_f32 v98, v98
    v_exp_f32 v99, v99
    v_mfma_f32_32x32x16_bf16 v[112:127], v[92:95], v[236:239], v[112:127]
    v_exp_f32 v100, v100
    v_exp_f32 v101, v101
    v_exp_f32 v102, v102
    v_exp_f32 v103, v103
    v_smfmac_f32_32x32x32_bf16 v[208:223], v[48:51], v[144:151], v30
    v_exp_f32 v104, v104
    v_exp_f32 v105, v105
    v_exp_f32 v106, v106
    v_exp_f32 v107, v107
    v_smfmac_f32_32x32x32_bf16 v[208:223], v[52:55], v[152:159], v30
    v_exp_f32 v108, v108
    v_exp_f32 v109, v109
    v_exp_f32 v110, v110
    v_exp_f32 v111, v111
    v_mfma_f32_32x32x16_bf16 v[128:143], v[88:91], v[240:243], 0
    v_exp_f32 v112, v112
    v_exp_f32 v113, v113
    v_exp_f32 v114, v114
    v_exp_f32 v115, v115
    v_mfma_f32_32x32x16_bf16 v[128:143], v[92:95], v[244:247], v[128:143]
    v_exp_f32 v116, v116
    v_exp_f32 v117, v117
    v_exp_f32 v118, v118
    v_exp_f32 v119, v119
    v_smfmac_f32_32x32x32_bf16 v[160:175], v[56:59], v[96:103], v30
    buffer_load_dwordx4 v[80:83], v27, s[40:43], s71 offen offset:3072 sc1
    buffer_load_dwordx4 v[84:87], v28, s[40:43], s71 offen offset:3072 sc1
    buffer_load_dwordx4 v[48:51], v29, s[40:43], s72 offen offset:1536 sc1
    buffer_load_dwordx4 v[52:55], v29, s[40:43], s72 offen offset:1664 sc1
    v_exp_f32 v120, v120
    v_exp_f32 v121, v121
    v_exp_f32 v122, v122
    v_exp_f32 v123, v123
    v_smfmac_f32_32x32x32_bf16 v[160:175], v[60:63], v[104:111], v30
    v_exp_f32 v124, v124
    v_exp_f32 v125, v125
    v_exp_f32 v126, v126
    v_exp_f32 v127, v127
    v_mfma_f32_32x32x16_bf16 v[144:159], v[88:91], v[248:251], 0
    v_exp_f32 v128, v128
    v_exp_f32 v129, v129
    v_exp_f32 v130, v130
    v_exp_f32 v131, v131
    v_mfma_f32_32x32x16_bf16 v[144:159], v[92:95], v[252:255], v[144:159]
    v_exp_f32 v132, v132
    v_exp_f32 v133, v133
    v_exp_f32 v134, v134
    v_exp_f32 v135, v135
    v_smfmac_f32_32x32x32_bf16 v[176:191], v[56:59], v[112:119], v30
    v_exp_f32 v136, v136
    v_exp_f32 v137, v137
    v_exp_f32 v138, v138
    v_exp_f32 v139, v139
    v_smfmac_f32_32x32x32_bf16 v[176:191], v[60:63], v[120:127], v30
    s_waitcnt vmcnt(8)
    v_exp_f32 v140, v140
    v_exp_f32 v141, v141
    v_exp_f32 v142, v142
    v_exp_f32 v143, v143
    v_mfma_f32_32x32x16_bf16 v[96:111], v[64:67], v[224:227], 0
    v_exp_f32 v144, v144
    v_exp_f32 v145, v145
    v_exp_f32 v146, v146
    v_exp_f32_e64 v147, v147
    v_mfma_f32_32x32x16_bf16 v[96:111], v[68:71], v[228:231], v[96:111]
    v_exp_f32 v148, v148
    v_exp_f32 v149, v149
    v_exp_f32 v150, v150
    v_exp_f32 v151, v151
    v_smfmac_f32_32x32x32_bf16 v[192:207], v[56:59], v[128:135], v30
    v_exp_f32 v152, v152
    v_exp_f32 v153, v153
    v_exp_f32 v154, v154
    v_exp_f32 v155, v155
    v_smfmac_f32_32x32x32_bf16 v[192:207], v[60:63], v[136:143], v30
    v_exp_f32 v156, v156
    v_exp_f32 v157, v157
    v_exp_f32 v158, v158
    v_exp_f32 v159, v159
    v_mfma_f32_32x32x16_bf16 v[112:127], v[64:67], v[232:235], 0
    v_exp_f32 v96, v96
    v_exp_f32 v97, v97
    v_exp_f32 v98, v98
    v_exp_f32 v99, v99
    v_mfma_f32_32x32x16_bf16 v[112:127], v[68:71], v[236:239], v[112:127]
    v_exp_f32 v100, v100
    v_exp_f32 v101, v101
    v_exp_f32 v102, v102
    v_exp_f32 v103, v103
    v_smfmac_f32_32x32x32_bf16 v[208:223], v[56:59], v[144:151], v30
    v_exp_f32 v104, v104
    v_exp_f32 v105, v105
    v_exp_f32 v106, v106
    v_exp_f32 v107, v107
    v_smfmac_f32_32x32x32_bf16 v[208:223], v[60:63], v[152:159], v30
    v_exp_f32 v108, v108
    v_exp_f32 v109, v109
    v_exp_f32 v110, v110
    v_exp_f32 v111, v111
    v_mfma_f32_32x32x16_bf16 v[128:143], v[64:67], v[240:243], 0
    v_exp_f32 v112, v112
    v_exp_f32 v113, v113
    v_exp_f32 v114, v114
    v_exp_f32 v115, v115
    v_mfma_f32_32x32x16_bf16 v[128:143], v[68:71], v[244:247], v[128:143]
    v_exp_f32 v116, v116
    v_exp_f32 v117, v117
    v_exp_f32 v118, v118
    v_exp_f32 v119, v119
    v_smfmac_f32_32x32x32_bf16 v[160:175], v[32:35], v[96:103], v30
    buffer_load_dwordx4 v[88:91], v27, s[40:43], s71 offen offset:3584 sc1
    buffer_load_dwordx4 v[92:95], v28, s[40:43], s71 offen offset:3584 sc1
    buffer_load_dwordx4 v[56:59], v29, s[40:43], s72 offen offset:1792 sc1
    buffer_load_dwordx4 v[60:63], v29, s[40:43], s72 offen offset:1920 sc1
    v_exp_f32 v120, v120
    v_exp_f32 v121, v121
    v_exp_f32 v122, v122
    v_exp_f32 v123, v123
    v_smfmac_f32_32x32x32_bf16 v[160:175], v[36:39], v[104:111], v30
    v_exp_f32 v124, v124
    v_exp_f32 v125, v125
    v_exp_f32 v126, v126
    v_exp_f32 v127, v127
    v_mfma_f32_32x32x16_bf16 v[144:159], v[64:67], v[248:251], 0
    v_exp_f32 v128, v128
    v_exp_f32 v129, v129
    v_exp_f32 v130, v130
    v_exp_f32 v131, v131
    v_mfma_f32_32x32x16_bf16 v[144:159], v[68:71], v[252:255], v[144:159]
    v_exp_f32 v132, v132
    v_exp_f32 v133, v133
    v_exp_f32 v134, v134
    v_exp_f32 v135, v135
    v_smfmac_f32_32x32x32_bf16 v[176:191], v[32:35], v[112:119], v30
    v_exp_f32 v136, v136
    v_exp_f32 v137, v137
    v_exp_f32 v138, v138
    v_exp_f32 v139, v139
    v_smfmac_f32_32x32x32_bf16 v[176:191], v[36:39], v[120:127], v30
    s_waitcnt vmcnt(8)
    v_exp_f32 v140, v140
    v_exp_f32 v141, v141
    v_exp_f32 v142, v142
    v_exp_f32 v143, v143
    v_mfma_f32_32x32x16_bf16 v[96:111], v[72:75], v[224:227], 0
    v_exp_f32 v144, v144
    v_exp_f32 v145, v145
    v_exp_f32 v146, v146
    v_exp_f32 v147, v147
    v_mfma_f32_32x32x16_bf16 v[96:111], v[76:79], v[228:231], v[96:111]
    v_exp_f32 v148, v148
    v_exp_f32 v149, v149
    v_exp_f32 v150, v150
    v_exp_f32_e64 v151, v151
    v_smfmac_f32_32x32x32_bf16 v[192:207], v[32:35], v[128:135], v30
    v_exp_f32 v152, v152
    v_exp_f32 v153, v153
    v_exp_f32 v154, v154
    v_exp_f32 v155, v155
    v_smfmac_f32_32x32x32_bf16 v[192:207], v[36:39], v[136:143], v30
    v_exp_f32 v156, v156
    v_exp_f32 v157, v157
    v_exp_f32 v158, v158
    v_exp_f32 v159, v159
    v_mfma_f32_32x32x16_bf16 v[112:127], v[72:75], v[232:235], 0
    v_exp_f32 v96, v96
    v_exp_f32 v97, v97
    v_exp_f32 v98, v98
    v_exp_f32 v99, v99
    v_mfma_f32_32x32x16_bf16 v[112:127], v[76:79], v[236:239], v[112:127]
    v_exp_f32 v100, v100
    v_exp_f32 v101, v101
    v_exp_f32 v102, v102
    v_exp_f32 v103, v103
    v_smfmac_f32_32x32x32_bf16 v[208:223], v[32:35], v[144:151], v30
    v_exp_f32 v104, v104
    v_exp_f32 v105, v105
    v_exp_f32 v106, v106
    v_exp_f32 v107, v107
    v_smfmac_f32_32x32x32_bf16 v[208:223], v[36:39], v[152:159], v30
    v_exp_f32 v108, v108
    v_exp_f32 v109, v109
    v_exp_f32 v110, v110
    v_exp_f32 v111, v111
    v_mfma_f32_32x32x16_bf16 v[128:143], v[72:75], v[240:243], 0
    v_exp_f32 v112, v112
    v_exp_f32 v113, v113
    v_exp_f32 v114, v114
    v_exp_f32 v115, v115
    v_mfma_f32_32x32x16_bf16 v[128:143], v[76:79], v[244:247], v[128:143]
    v_exp_f32 v116, v116
    v_exp_f32 v117, v117
    v_exp_f32 v118, v118
    v_exp_f32 v119, v119
    v_smfmac_f32_32x32x32_bf16 v[160:175], v[40:43], v[96:103], v30
    buffer_load_dwordx4 v[64:67], v27, s[40:43], s63 offen offset:0 sc1
    buffer_load_dwordx4 v[68:71], v28, s[40:43], s63 offen offset:0 sc1
    buffer_load_dwordx4 v[32:35], v29, s[40:43], s72 offen offset:2048 sc1
    buffer_load_dwordx4 v[36:39], v29, s[40:43], s72 offen offset:2176 sc1
    v_exp_f32 v120, v120
    v_exp_f32 v121, v121
    v_exp_f32 v122, v122
    v_exp_f32 v123, v123
    v_smfmac_f32_32x32x32_bf16 v[160:175], v[44:47], v[104:111], v30
    v_exp_f32 v124, v124
    v_exp_f32 v125, v125
    v_exp_f32 v126, v126
    v_exp_f32 v127, v127
    v_mfma_f32_32x32x16_bf16 v[144:159], v[72:75], v[248:251], 0
    v_exp_f32 v128, v128
    v_exp_f32 v129, v129
    v_exp_f32 v130, v130
    v_exp_f32 v131, v131
    v_mfma_f32_32x32x16_bf16 v[144:159], v[76:79], v[252:255], v[144:159]
    v_exp_f32 v132, v132
    v_exp_f32 v133, v133
    v_exp_f32 v134, v134
    v_exp_f32 v135, v135
    v_smfmac_f32_32x32x32_bf16 v[176:191], v[40:43], v[112:119], v30
    v_exp_f32 v136, v136
L_pad9:
    s_cbranch_execz L_pad_ret
    v_exp_f32 v137, v137
    v_exp_f32 v138, v138
    v_exp_f32_e64 v139, v139
    v_smfmac_f32_32x32x32_bf16 v[176:191], v[44:47], v[120:127], v30
    s_waitcnt vmcnt(8)
    v_exp_f32 v140, v140
    v_exp_f32 v141, v141
    v_exp_f32 v142, v142
    v_exp_f32_e64 v143, v143
    v_mfma_f32_32x32x16_bf16 v[96:111], v[80:83], v[224:227], 0
    v_exp_f32 v144, v144
    v_exp_f32 v145, v145
    v_exp_f32 v146, v146
    v_exp_f32 v147, v147
    v_mfma_f32_32x32x16_bf16 v[96:111], v[84:87], v[228:231], v[96:111]
    v_exp_f32 v148, v148
    v_exp_f32 v149, v149
    v_exp_f32 v150, v150
    v_exp_f32 v151, v151
    v_smfmac_f32_32x32x32_bf16 v[192:207], v[40:43], v[128:135], v30
    v_exp_f32 v152, v152
    v_exp_f32 v153, v153
    v_exp_f32 v154, v154
    v_exp_f32 v155, v155
    v_smfmac_f32_32x32x32_bf16 v[192:207], v[44:47], v[136:143], v30
    v_exp_f32 v156, v156
    v_exp_f32 v157, v157
    v_exp_f32 v158, v158
    v_exp_f32 v159, v159
    v_mfma_f32_32x32x16_bf16 v[112:127], v[80:83], v[232:235], 0
    v_exp_f32 v96, v96
    v_exp_f32 v97, v97
    v_exp_f32 v98, v98
    v_exp_f32 v99, v99
    v_mfma_f32_32x32x16_bf16 v[112:127], v[84:87], v[236:239], v[112:127]
    v_exp_f32 v100, v100
    v_exp_f32 v101, v101
    v_exp_f32 v102, v102
    v_exp_f32 v103, v103
    v_smfmac_f32_32x32x32_bf16 v[208:223], v[40:43], v[144:151], v30
    v_exp_f32 v104, v104
    v_exp_f32 v105, v105
    v_exp_f32 v106, v106
    v_exp_f32 v107, v107
    v_smfmac_f32_32x32x32_bf16 v[208:223], v[44:47], v[152:159], v30
    v_exp_f32 v108, v108
    v_exp_f32 v109, v109
    v_exp_f32 v110, v110
    v_exp_f32 v111, v111
    v_mfma_f32_32x32x16_bf16 v[128:143], v[80:83], v[240:243], 0
    v_exp_f32 v112, v112
    v_exp_f32 v113, v113
    v_exp_f32 v114, v114
    v_exp_f32 v115, v115
    v_mfma_f32_32x32x16_bf16 v[128:143], v[84:87], v[244:247], v[128:143]
    v_exp_f32 v116, v116
    v_exp_f32 v117, v117
    v_exp_f32 v118, v118
    v_exp_f32 v119, v119
    v_smfmac_f32_32x32x32_bf16 v[160:175], v[48:51], v[96:103], v30
    buffer_load_dwordx4 v[72:75], v27, s[40:43], s63 offen offset:512 sc1
    buffer_load_dwordx4 v[76:79], v28, s[40:43], s63 offen offset:512 sc1
    buffer_load_dwordx4 v[40:43], v29, s[40:43], s72 offen offset:2304 sc1
    buffer_load_dwordx4 v[44:47], v29, s[40:43], s72 offen offset:2432 sc1
    v_exp_f32 v120, v120
    v_exp_f32 v121, v121
    v_exp_f32 v122, v122
    v_exp_f32 v123, v123
    v_smfmac_f32_32x32x32_bf16 v[160:175], v[52:55], v[104:111], v30
    v_exp_f32 v124, v124
    v_exp_f32 v125, v125
    v_exp_f32 v126, v126
    v_exp_f32 v127, v127
    v_mfma_f32_32x32x16_bf16 v[144:159], v[80:83], v[248:251], 0
    v_exp_f32 v128, v128
    v_exp_f32 v129, v129
    v_exp_f32 v130, v130
    v_exp_f32 v131, v131
    v_mfma_f32_32x32x16_bf16 v[144:159], v[84:87], v[252:255], v[144:159]
    v_exp_f32 v132, v132
    v_exp_f32 v133, v133
    v_exp_f32 v134, v134
    v_exp_f32 v135, v135
    v_smfmac_f32_32x32x32_bf16 v[176:191], v[48:51], v[112:119], v30
    v_exp_f32 v136, v136
    v_exp_f32 v137, v137
    v_exp_f32 v138, v138
    v_exp_f32 v139, v139
    v_smfmac_f32_32x32x32_bf16 v[176:191], v[52:55], v[120:127], v30
    s_waitcnt vmcnt(8)
    v_exp_f32 v140, v140
    v_exp_f32 v141, v141
    v_exp_f32 v142, v142
    v_exp_f32 v143, v143
    v_mfma_f32_32x32x16_bf16 v[96:111], v[88:91], v[224:227], 0
    v_exp_f32 v144, v144
    v_exp_f32 v145, v145
    v_exp_f32 v146, v146
    v_exp_f32_e64 v147, v147
    v_mfma_f32_32x32x16_bf16 v[96:111], v[92:95], v[228:231], v[96:111]
    v_exp_f32 v148, v148
    v_exp_f32 v149, v149
    v_exp_f32 v150, v150
    v_exp_f32 v151, v151
    v_smfmac_f32_32x32x32_bf16 v[192:207], v[48:51], v[128:135], v30
    v_exp_f32 v152, v152
    v_exp_f32 v153, v153
    v_exp_f32 v154, v154
    v_exp_f32 v155, v155
    v_smfmac_f32_32x32x32_bf16 v[192:207], v[52:55], v[136:143], v30
    v_exp_f32 v156, v156
    v_exp_f32 v157, v157
    v_exp_f32 v158, v158
    v_exp_f32 v159, v159
    v_mfma_f32_32x32x16_bf16 v[112:127], v[88:91], v[232:235], 0
    v_exp_f32 v96, v96
    v_exp_f32 v97, v97
    v_exp_f32 v98, v98
    v_exp_f32 v99, v99
    v_mfma_f32_32x32x16_bf16 v[112:127], v[92:95], v[236:239], v[112:127]
    v_exp_f32 v100, v100
    v_exp_f32 v101, v101
    v_exp_f32 v102, v102
    v_exp_f32 v103, v103
    v_smfmac_f32_32x32x32_bf16 v[208:223], v[48:51], v[144:151], v30
    v_exp_f32 v104, v104
    v_exp_f32 v105, v105
    v_exp_f32 v106, v106
    v_exp_f32 v107, v107
    v_smfmac_f32_32x32x32_bf16 v[208:223], v[52:55], v[152:159], v30
    v_exp_f32 v108, v108
    v_exp_f32 v109, v109
    v_exp_f32 v110, v110
    v_exp_f32 v111, v111
    v_mfma_f32_32x32x16_bf16 v[128:143], v[88:91], v[240:243], 0
    v_exp_f32 v112, v112
    v_exp_f32 v113, v113
    v_exp_f32 v114, v114
    v_exp_f32 v115, v115
    v_mfma_f32_32x32x16_bf16 v[128:143], v[92:95], v[244:247], v[128:143]
    v_exp_f32 v116, v116
    v_exp_f32 v117, v117
    v_exp_f32 v118, v118
    v_exp_f32 v119, v119
    v_smfmac_f32_32x32x32_bf16 v[160:175], v[56:59], v[96:103], v30
    buffer_load_dwordx4 v[80:83], v27, s[40:43], s63 offen offset:1024 sc1
    buffer_load_dwordx4 v[84:87], v28, s[40:43], s63 offen offset:1024 sc1
    buffer_load_dwordx4 v[48:51], v29, s[40:43], s72 offen offset:2560 sc1
    buffer_load_dwordx4 v[52:55], v29, s[40:43], s72 offen offset:2688 sc1
    v_exp_f32 v120, v120
    v_exp_f32 v121, v121
    v_exp_f32 v122, v122
    v_exp_f32 v123, v123
    v_smfmac_f32_32x32x32_bf16 v[160:175], v[60:63], v[104:111], v30
    v_exp_f32 v124, v124
    v_exp_f32 v125, v125
    v_exp_f32 v126, v126
    v_exp_f32 v127, v127
    v_mfma_f32_32x32x16_bf16 v[144:159], v[88:91], v[248:251], 0
    v_exp_f32 v128, v128
    v_exp_f32 v129, v129
    v_exp_f32 v130, v130
    v_exp_f32 v131, v131
    v_mfma_f32_32x32x16_bf16 v[144:159], v[92:95], v[252:255], v[144:159]
    v_exp_f32 v132, v132
    v_exp_f32 v133, v133
    v_exp_f32 v134, v134
    v_exp_f32 v135, v135
    v_smfmac_f32_32x32x32_bf16 v[176:191], v[56:59], v[112:119], v30
    v_exp_f32 v136, v136
    v_exp_f32 v137, v137
    v_exp_f32 v138, v138
    v_exp_f32 v139, v139
    v_smfmac_f32_32x32x32_bf16 v[176:191], v[60:63], v[120:127], v30
    s_waitcnt vmcnt(8)
    v_exp_f32 v140, v140
    v_exp_f32 v141, v141
    v_exp_f32 v142, v142
    v_exp_f32 v143, v143
    v_mfma_f32_32x32x16_bf16 v[96:111], v[64:67], v[224:227], 0
    v_exp_f32 v144, v144
    v_exp_f32 v145, v145
    v_exp_f32 v146, v146
    v_exp_f32 v147, v147
    v_mfma_f32_32x32x16_bf16 v[96:111], v[68:71], v[228:231], v[96:111]
    v_exp_f32 v148, v148
    v_exp_f32 v149, v149
    v_exp_f32 v150, v150
    v_exp_f32_e64 v151, v151
    v_smfmac_f32_32x32x32_bf16 v[192:207], v[56:59], v[128:135], v30
    v_exp_f32 v152, v152
    v_exp_f32 v153, v153
    v_exp_f32 v154, v154
    v_exp_f32 v155, v155
    v_smfmac_f32_32x32x32_bf16 v[192:207], v[60:63], v[136:143], v30
    v_exp_f32 v156, v156
    v_exp_f32 v157, v157
    v_exp_f32 v158, v158
    v_exp_f32 v159, v159
    v_mfma_f32_32x32x16_bf16 v[112:127], v[64:67], v[232:235], 0
    v_exp_f32 v96, v96
    v_exp_f32 v97, v97
    v_exp_f32 v98, v98
    v_exp_f32 v99, v99
    v_mfma_f32_32x32x16_bf16 v[112:127], v[68:71], v[236:239], v[112:127]
    v_exp_f32 v100, v100
    v_exp_f32 v101, v101
    v_exp_f32 v102, v102
    v_exp_f32 v103, v103
    v_smfmac_f32_32x32x32_bf16 v[208:223], v[56:59], v[144:151], v30
    v_exp_f32 v104, v104
    v_exp_f32 v105, v105
    v_exp_f32 v106, v106
    v_exp_f32 v107, v107
    v_smfmac_f32_32x32x32_bf16 v[208:223], v[60:63], v[152:159], v30
    v_exp_f32 v108, v108
    v_exp_f32 v109, v109
    v_exp_f32 v110, v110
    v_exp_f32 v111, v111
    v_mfma_f32_32x32x16_bf16 v[128:143], v[64:67], v[240:243], 0
    v_exp_f32 v112, v112
    v_exp_f32 v113, v113
    v_exp_f32 v114, v114
    v_exp_f32 v115, v115
    v_mfma_f32_32x32x16_bf16 v[128:143], v[68:71], v[244:247], v[128:143]
    v_exp_f32 v116, v116
    v_exp_f32 v117, v117
    v_exp_f32 v118, v118
    v_exp_f32 v119, v119
    v_smfmac_f32_32x32x32_bf16 v[160:175], v[32:35], v[96:103], v30
    buffer_load_dwordx4 v[88:91], v27, s[40:43], s63 offen offset:1536 sc1
    buffer_load_dwordx4 v[92:95], v28, s[40:43], s63 offen offset:1536 sc1
    buffer_load_dwordx4 v[56:59], v29, s[40:43], s72 offen offset:2816 sc1
    buffer_load_dwordx4 v[60:63], v29, s[40:43], s72 offen offset:2944 sc1
    v_exp_f32 v120, v120
    v_exp_f32 v121, v121
    v_exp_f32 v122, v122
    v_exp_f32 v123, v123
    v_smfmac_f32_32x32x32_bf16 v[160:175], v[36:39], v[104:111], v30
    v_exp_f32 v124, v124
    v_exp_f32 v125, v125
    v_exp_f32 v126, v126
    v_exp_f32 v127, v127
L_pad10:
    s_cbranch_execz L_pad_ret
    v_mfma_f32_32x32x16_bf16 v[144:159], v[64:67], v[248:251], 0
    v_exp_f32 v128, v128
    v_exp_f32 v129, v129
    v_exp_f32 v130, v130
    v_exp_f32 v131, v131
    v_mfma_f32_32x32x16_bf16 v[144:159], v[68:71], v[252:255], v[144:159]
    v_exp_f32 v132, v132
    v_exp_f32 v133, v133
    v_exp_f32 v134, v134
    v_exp_f32 v135, v135
    v_smfmac_f32_32x32x32_bf16 v[176:191], v[32:35], v[112:119], v30
    v_exp_f32 v136, v136
    v_exp_f32 v137, v137
    v_exp_f32 v138, v138
    v_exp_f32_e64 v139, v139
    v_smfmac_f32_32x32x32_bf16 v[176:191], v[36:39], v[120:127], v30
    s_waitcnt vmcnt(8)
    v_exp_f32 v140, v140
    v_exp_f32 v141, v141
    v_exp_f32 v142, v142
    v_exp_f32_e64 v143, v143
    v_mfma_f32_32x32x16_bf16 v[96:111], v[72:75], v[224:227], 0
    v_exp_f32 v144, v144
    v_exp_f32 v145, v145
    v_exp_f32 v146, v146
    v_exp_f32 v147, v147
    v_mfma_f32_32x32x16_bf16 v[96:111], v[76:79], v[228:231], v[96:111]
    v_exp_f32 v148, v148
    v_exp_f32 v149, v149
    v_exp_f32 v150, v150
    v_exp_f32 v151, v151
    v_smfmac_f32_32x32x32_bf16 v[192:207], v[32:35], v[128:135], v30
    v_exp_f32 v152, v152
    v_exp_f32 v153, v153
    v_exp_f32 v154, v154
    v_exp_f32 v155, v155
    v_smfmac_f32_32x32x32_bf16 v[192:207], v[36:39], v[136:143], v30
    v_exp_f32 v156, v156
    v_exp_f32 v157, v157
    v_exp_f32 v158, v158
    v_exp_f32 v159, v159
    v_mfma_f32_32x32x16_bf16 v[112:127], v[72:75], v[232:235], 0
    v_exp_f32 v96, v96
    v_exp_f32 v97, v97
    v_exp_f32 v98, v98
    v_exp_f32 v99, v99
    v_mfma_f32_32x32x16_bf16 v[112:127], v[76:79], v[236:239], v[112:127]
    v_exp_f32 v100, v100
    v_exp_f32 v101, v101
    v_exp_f32 v102, v102
    v_exp_f32 v103, v103
    v_smfmac_f32_32x32x32_bf16 v[208:223], v[32:35], v[144:151], v30
    v_exp_f32 v104, v104
    v_exp_f32 v105, v105
    v_exp_f32 v106, v106
    v_exp_f32 v107, v107
    v_smfmac_f32_32x32x32_bf16 v[208:223], v[36:39], v[152:159], v30
    v_exp_f32 v108, v108
    v_exp_f32 v109, v109
    v_exp_f32 v110, v110
    v_exp_f32 v111, v111
    v_mfma_f32_32x32x16_bf16 v[128:143], v[72:75], v[240:243], 0
    v_exp_f32 v112, v112
    v_exp_f32 v113, v113
    v_exp_f32 v114, v114
    v_exp_f32 v115, v115
    v_mfma_f32_32x32x16_bf16 v[128:143], v[76:79], v[244:247], v[128:143]
    v_exp_f32 v116, v116
    v_exp_f32 v117, v117
    v_exp_f32 v118, v118
    v_exp_f32 v119, v119
    v_smfmac_f32_32x32x32_bf16 v[160:175], v[40:43], v[96:103], v30
    buffer_load_dwordx4 v[64:67], v27, s[40:43], s63 offen offset:2048 sc1
    buffer_load_dwordx4 v[68:71], v28, s[40:43], s63 offen offset:2048 sc1
    buffer_load_dwordx4 v[32:35], v29, s[40:43], s72 offen offset:3072 sc1
    buffer_load_dwordx4 v[36:39], v29, s[40:43], s72 offen offset:3200 sc1
    v_exp_f32 v120, v120
    v_exp_f32 v121, v121
    v_exp_f32 v122, v122
    v_exp_f32 v123, v123
    v_smfmac_f32_32x32x32_bf16 v[160:175], v[44:47], v[104:111], v30
    v_exp_f32 v124, v124
    v_exp_f32 v125, v125
    v_exp_f32 v126, v126
    v_exp_f32 v127, v127
    v_mfma_f32_32x32x16_bf16 v[144:159], v[72:75], v[248:251], 0
    v_exp_f32 v128, v128
    v_exp_f32 v129, v129
    v_exp_f32 v130, v130
    v_exp_f32 v131, v131
    v_mfma_f32_32x32x16_bf16 v[144:159], v[76:79], v[252:255], v[144:159]
    v_exp_f32 v132, v132
    v_exp_f32 v133, v133
    v_exp_f32 v134, v134
    v_exp_f32 v135, v135
    v_smfmac_f32_32x32x32_bf16 v[176:191], v[40:43], v[112:119], v30
    v_exp_f32 v136, v136
    v_exp_f32 v137, v137
    v_exp_f32 v138, v138
    v_exp_f32 v139, v139
    v_smfmac_f32_32x32x32_bf16 v[176:191], v[44:47], v[120:127], v30
    s_waitcnt vmcnt(8)
    v_exp_f32 v140, v140
    v_exp_f32 v141, v141
    v_exp_f32 v142, v142
    v_exp_f32 v143, v143
    v_mfma_f32_32x32x16_bf16 v[96:111], v[80:83], v[224:227], 0
    v_exp_f32 v144, v144
    v_exp_f32 v145, v145
    v_exp_f32 v146, v146
    v_exp_f32_e64 v147, v147
    v_mfma_f32_32x32x16_bf16 v[96:111], v[84:87], v[228:231], v[96:111]
    v_exp_f32 v148, v148
    v_exp_f32 v149, v149
    v_exp_f32 v150, v150
    v_exp_f32 v151, v151
    v_smfmac_f32_32x32x32_bf16 v[192:207], v[40:43], v[128:135], v30
    v_exp_f32 v152, v152
    v_exp_f32 v153, v153
    v_exp_f32 v154, v154
    v_exp_f32 v155, v155
    v_smfmac_f32_32x32x32_bf16 v[192:207], v[44:47], v[136:143], v30
    v_exp_f32 v156, v156
    v_exp_f32 v157, v157
    v_exp_f32 v158, v158
    v_exp_f32 v159, v159
    v_mfma_f32_32x32x16_bf16 v[112:127], v[80:83], v[232:235], 0
    v_exp_f32 v96, v96
    v_exp_f32 v97, v97
    v_exp_f32 v98, v98
    v_exp_f32 v99, v99
    v_mfma_f32_32x32x16_bf16 v[112:127], v[84:87], v[236:239], v[112:127]
    v_exp_f32 v100, v100
    v_exp_f32 v101, v101
    v_exp_f32 v102, v102
    v_exp_f32 v103, v103
    v_smfmac_f32_32x32x32_bf16 v[208:223], v[40:43], v[144:151], v30
    v_exp_f32 v104, v104
    v_exp_f32 v105, v105
    v_exp_f32 v106, v106
    v_exp_f32 v107, v107
    v_smfmac_f32_32x32x32_bf16 v[208:223], v[44:47], v[152:159], v30
    v_exp_f32 v108, v108
    v_exp_f32 v109, v109
    v_exp_f32 v110, v110
    v_exp_f32 v111, v111
    v_mfma_f32_32x32x16_bf16 v[128:143], v[80:83], v[240:243], 0
    v_exp_f32 v112, v112
    v_exp_f32 v113, v113
    v_exp_f32 v114, v114
    v_exp_f32 v115, v115
    v_mfma_f32_32x32x16_bf16 v[128:143], v[84:87], v[244:247], v[128:143]
    v_exp_f32 v116, v116
    v_exp_f32 v117, v117
    v_exp_f32 v118, v118
    v_exp_f32 v119, v119
    v_smfmac_f32_32x32x32_bf16 v[160:175], v[48:51], v[96:103], v30
    buffer_load_dwordx4 v[72:75], v27, s[40:43], s63 offen offset:2560 sc1
    buffer_load_dwordx4 v[76:79], v28, s[40:43], s63 offen offset:2560 sc1
    buffer_load_dwordx4 v[40:43], v29, s[40:43], s72 offen offset:3328 sc1
    buffer_load_dwordx4 v[44:47], v29, s[40:43], s72 offen offset:3456 sc1
    v_exp_f32 v120, v120
    v_exp_f32 v121, v121
    v_exp_f32 v122, v122
    v_exp_f32 v123, v123
    v_smfmac_f32_32x32x32_bf16 v[160:175], v[52:55], v[104:111], v30
    v_exp_f32 v124, v124
    v_exp_f32 v125, v125
    v_exp_f32 v126, v126
    v_exp_f32 v127, v127
    v_mfma_f32_32x32x16_bf16 v[144:159], v[80:83], v[248:251], 0
    v_exp_f32 v128, v128
    v_exp_f32 v129, v129
    v_exp_f32 v130, v130
    v_exp_f32 v131, v131
    v_mfma_f32_32x32x16_bf16 v[144:159], v[84:87], v[252:255], v[144:159]
    v_exp_f32 v132, v132
    v_exp_f32 v133, v133
    v_exp_f32 v134, v134
    v_exp_f32 v135, v135
    v_smfmac_f32_32x32x32_bf16 v[176:191], v[48:51], v[112:119], v30
    v_exp_f32 v136, v136
    v_exp_f32 v137, v137
    v_exp_f32 v138, v138
    v_exp_f32 v139, v139
    v_smfmac_f32_32x32x32_bf16 v[176:191], v[52:55], v[120:127], v30
    s_waitcnt vmcnt(8)
    v_exp_f32 v140, v140
    v_exp_f32 v141, v141
    v_exp_f32 v142, v142
    v_exp_f32 v143, v143
    v_mfma_f32_32x32x16_bf16 v[96:111], v[88:91], v[224:227], 0
    v_exp_f32 v144, v144
    v_exp_f32 v145, v145
    v_exp_f32 v146, v146
    v_exp_f32 v147, v147
    v_mfma_f32_32x32x16_bf16 v[96:111], v[92:95], v[228:231], v[96:111]
    v_exp_f32 v148, v148
    v_exp_f32 v149, v149
    v_exp_f32 v150, v150
    v_exp_f32_e64 v151, v151
    v_smfmac_f32_32x32x32_bf16 v[192:207], v[48:51], v[128:135], v30
    v_exp_f32 v152, v152
    v_exp_f32 v153, v153
    v_exp_f32 v154, v154
    v_exp_f32 v155, v155
    v_smfmac_f32_32x32x32_bf16 v[192:207], v[52:55], v[136:143], v30
    v_exp_f32 v156, v156
    v_exp_f32 v157, v157
    v_exp_f32 v158, v158
    v_exp_f32 v159, v159
    v_mfma_f32_32x32x16_bf16 v[112:127], v[88:91], v[232:235], 0
    v_exp_f32 v96, v96
    v_exp_f32 v97, v97
    v_exp_f32 v98, v98
    v_exp_f32 v99, v99
    v_mfma_f32_32x32x16_bf16 v[112:127], v[92:95], v[236:239], v[112:127]
    v_exp_f32 v100, v100
    v_exp_f32 v101, v101
    v_exp_f32 v102, v102
    v_exp_f32 v103, v103
    v_smfmac_f32_32x32x32_bf16 v[208:223], v[48:51], v[144:151], v30
    v_exp_f32 v104, v104
    v_exp_f32 v105, v105
    v_exp_f32 v106, v106
    v_exp_f32 v107, v107
    v_smfmac_f32_32x32x32_bf16 v[208:223], v[52:55], v[152:159], v30
    v_exp_f32 v108, v108
    v_exp_f32 v109, v109
    v_exp_f32 v110, v110
    v_exp_f32 v111, v111
    v_mfma_f32_32x32x16_bf16 v[128:143], v[88:91], v[240:243], 0
    v_exp_f32 v112, v112
    v_exp_f32 v113, v113
    v_exp_f32 v114, v114
    v_exp_f32 v115, v115
    v_mfma_f32_32x32x16_bf16 v[128:143], v[92:95], v[244:247], v[128:143]
    v_exp_f32 v116, v116
    v_exp_f32 v117, v117
    v_exp_f32 v118, v118
    v_exp_f32 v119, v119
    v_smfmac_f32_32x32x32_bf16 v[160:175], v[56:59], v[96:103], v30
    buffer_load_dwordx4 v[80:83], v27, s[40:43], s63 offen offset:3072 sc1
    buffer_load_dwordx4 v[84:87], v28, s[40:43], s63 offen offset:3072 sc1
L_pad11:
    s_cbranch_execz L_pad_ret
    buffer_load_dwordx4 v[48:51], v29, s[40:43], s72 offen offset:3584 sc1
    buffer_load_dwordx4 v[52:55], v29, s[40:43], s72 offen offset:3712 sc1
    v_exp_f32 v120, v120
    v_exp_f32 v121, v121
    v_exp_f32 v122, v122
    v_exp_f32_e64 v123, v123
    v_smfmac_f32_32x32x32_bf16 v[160:175], v[60:63], v[104:111], v30
    v_exp_f32 v124, v124
    v_exp_f32 v125, v125
    v_exp_f32 v126, v126
    v_exp_f32 v127, v127
    v_mfma_f32_32x32x16_bf16 v[144:159], v[88:91], v[248:251], 0
    v_exp_f32 v128, v128
    v_exp_f32 v129, v129
    v_exp_f32 v130, v130
    v_exp_f32 v131, v131
    v_mfma_f32_32x32x16_bf16 v[144:159], v[92:95], v[252:255], v[144:159]
    v_exp_f32 v132, v132
    v_exp_f32 v133, v133
    v_exp_f32 v134, v134
    v_exp_f32 v135, v135
    v_smfmac_f32_32x32x32_bf16 v[176:191], v[56:59], v[112:119], v30
    v_exp_f32 v136, v136
    v_exp_f32 v137, v137
    v_exp_f32 v138, v138
    v_exp_f32 v139, v139
    v_smfmac_f32_32x32x32_bf16 v[176:191], v[60:63], v[120:127], v30
    s_waitcnt vmcnt(8)
    v_exp_f32 v140, v140
    v_exp_f32 v141, v141
    v_exp_f32 v142, v142
    v_exp_f32_e64 v143, v143
    v_mfma_f32_32x32x16_bf16 v[96:111], v[64:67], v[224:227], 0
    v_exp_f32 v144, v144
    v_exp_f32 v145, v145
    v_exp_f32 v146, v146
    v_exp_f32 v147, v147
    v_mfma_f32_32x32x16_bf16 v[96:111], v[68:71], v[228:231], v[96:111]
    v_exp_f32 v148, v148
    v_exp_f32 v149, v149
    v_exp_f32 v150, v150
    v_exp_f32 v151, v151
    v_smfmac_f32_32x32x32_bf16 v[192:207], v[56:59], v[128:135], v30
    v_exp_f32 v152, v152
    v_exp_f32 v153, v153
    v_exp_f32 v154, v154
    v_exp_f32 v155, v155
    v_smfmac_f32_32x32x32_bf16 v[192:207], v[60:63], v[136:143], v30
    v_exp_f32 v156, v156
    v_exp_f32 v157, v157
    v_exp_f32 v158, v158
    v_exp_f32 v159, v159
    v_mfma_f32_32x32x16_bf16 v[112:127], v[64:67], v[232:235], 0
    v_exp_f32 v96, v96
    v_exp_f32 v97, v97
    v_exp_f32 v98, v98
    v_exp_f32 v99, v99
    v_mfma_f32_32x32x16_bf16 v[112:127], v[68:71], v[236:239], v[112:127]
    v_exp_f32 v100, v100
    v_exp_f32 v101, v101
    v_exp_f32 v102, v102
    v_exp_f32 v103, v103
    v_smfmac_f32_32x32x32_bf16 v[208:223], v[56:59], v[144:151], v30
    v_exp_f32 v104, v104
    v_exp_f32 v105, v105
    v_exp_f32 v106, v106
    v_exp_f32 v107, v107
    v_smfmac_f32_32x32x32_bf16 v[208:223], v[60:63], v[152:159], v30
    v_exp_f32 v108, v108
    v_exp_f32 v109, v109
    v_exp_f32 v110, v110
    v_exp_f32 v111, v111
    v_mfma_f32_32x32x16_bf16 v[128:143], v[64:67], v[240:243], 0
    v_exp_f32 v112, v112
    v_exp_f32 v113, v113
    v_exp_f32 v114, v114
    v_exp_f32 v115, v115
    v_mfma_f32_32x32x16_bf16 v[128:143], v[68:71], v[244:247], v[128:143]
    v_exp_f32 v116, v116
    v_exp_f32 v117, v117
    v_exp_f32 v118, v118
    v_exp_f32 v119, v119
    v_smfmac_f32_32x32x32_bf16 v[160:175], v[32:35], v[96:103], v30
    buffer_load_dwordx4 v[88:91], v27, s[40:43], s63 offen offset:3584 sc1
    buffer_load_dwordx4 v[92:95], v28, s[40:43], s63 offen offset:3584 sc1
    buffer_load_dwordx4 v[56:59], v29, s[40:43], s72 offen offset:3840 sc1
    buffer_load_dwordx4 v[60:63], v29, s[40:43], s72 offen offset:3968 sc1
    v_exp_f32 v120, v120
    v_exp_f32 v121, v121
    v_exp_f32 v122, v122
    v_exp_f32 v123, v123
    v_smfmac_f32_32x32x32_bf16 v[160:175], v[36:39], v[104:111], v30
L_pg1:
    s_cbranch_execz L_pg_ret
    s_waitcnt vmcnt(8)
    v_exp_f32 v124, v124
    v_exp_f32 v125, v125
    v_exp_f32 v126, v126
    v_exp_f32 v127, v127
    v_mfma_f32_32x32x16_bf16 v[144:159], v[72:75], v[224:227], 0
    v_exp_f32 v128, v128
    v_exp_f32 v129, v129
    v_exp_f32 v130, v130
    v_exp_f32 v131, v131
    v_mfma_f32_32x32x16_bf16 v[144:159], v[76:79], v[228:231], v[144:159]
    v_exp_f32 v132, v132
    v_exp_f32 v133, v133
    v_exp_f32 v134, v134
    v_exp_f32 v135, v135
    v_smfmac_f32_32x32x32_bf16 v[176:191], v[32:35], v[112:119], v30
    v_exp_f32 v136, v136
    v_exp_f32 v137, v137
    v_exp_f32 v138, v138
    v_exp_f32 v139, v139
    v_smfmac_f32_32x32x32_bf16 v[176:191], v[36:39], v[120:127], v30
    v_exp_f32 v140, v140
    v_exp_f32 v141, v141
    v_exp_f32 v142, v142
    v_exp_f32 v143, v143
    v_mfma_f32_32x32x16_bf16 v[96:111], v[72:75], v[232:235], 0
    v_exp_f32 v144, v144
    v_exp_f32 v145, v145
    v_exp_f32 v146, v146
    v_exp_f32 v147, v147
    v_mfma_f32_32x32x16_bf16 v[96:111], v[76:79], v[236:239], v[96:111]
    v_exp_f32 v148, v148
    v_exp_f32 v149, v149
    v_exp_f32 v150, v150
    v_exp_f32 v151, v151
    v_smfmac_f32_32x32x32_bf16 v[192:207], v[32:35], v[128:135], v30
    v_exp_f32 v152, v152
    v_exp_f32 v153, v153
    v_exp_f32 v154, v154
    v_exp_f32 v155, v155
    v_smfmac_f32_32x32x32_bf16 v[192:207], v[36:39], v[136:143], v30
    v_exp_f32 v156, v156
    v_exp_f32 v157, v157
    v_exp_f32 v158, v158
    v_exp_f32 v159, v159
    v_mfma_f32_32x32x16_bf16 v[112:127], v[72:75], v[240:243], 0
    v_exp_f32 v96, v96
    v_exp_f32 v97, v97
    v_exp_f32 v98, v98
    v_exp_f32 v99, v99
    v_mfma_f32_32x32x16_bf16 v[112:127], v[76:79], v[244:247], v[112:127]
    v_exp_f32 v100, v100
    v_exp_f32 v101, v101
    v_exp_f32 v102, v102
    v_exp_f32 v103, v103
    v_smfmac_f32_32x32x32_bf16 v[160:175], v[40:43], v[144:151], v30
    v_exp_f32 v104, v104
    v_exp_f32 v105, v105
    v_exp_f32 v106, v106
    v_exp_f32 v107, v107
    v_smfmac_f32_32x32x32_bf16 v[160:175], v[44:47], v[152:159], v30
    s_waitcnt vmcnt(4)
    v_exp_f32 v108, v108
    v_exp_f32 v109, v109
    v_exp_f32 v110, v110
    v_exp_f32 v111, v111
    v_mfma_f32_32x32x16_bf16 v[128:143], v[80:83], v[224:227], 0
    v_exp_f32 v112, v112
    v_exp_f32 v113, v113
    v_exp_f32 v114, v114
    v_exp_f32 v115, v115
    v_mfma_f32_32x32x16_bf16 v[128:143], v[84:87], v[228:231], v[128:143]
    v_exp_f32 v116, v116
    v_exp_f32 v117, v117
    v_exp_f32 v118, v118
    v_exp_f32_e64 v119, v119
    v_smfmac_f32_32x32x32_bf16 v[176:191], v[40:43], v[96:103], v30
    v_exp_f32 v120, v120
    v_exp_f32 v121, v121
    v_exp_f32 v122, v122
    v_exp_f32 v123, v123
    v_smfmac_f32_32x32x32_bf16 v[176:191], v[44:47], v[104:111], v30
    v_exp_f32 v124, v124
    v_exp_f32 v125, v125
    v_exp_f32 v126, v126
    v_exp_f32 v127, v127
    v_mfma_f32_32x32x16_bf16 v[144:159], v[80:83], v[232:235], 0
    v_exp_f32 v128, v128
    v_exp_f32 v129, v129
    v_exp_f32 v130, v130
    v_exp_f32 v131, v131
    v_mfma_f32_32x32x16_bf16 v[144:159], v[84:87], v[236:239], v[144:159]
    v_exp_f32 v132, v132
    v_exp_f32 v133, v133
    v_exp_f32 v134, v134
    v_exp_f32 v135, v135
    v_smfmac_f32_32x32x32_bf16 v[192:207], v[40:43], v[112:119], v30
    v_exp_f32 v136, v136
    v_exp_f32 v137, v137
    v_exp_f32 v138, v138
    v_exp_f32 v139, v139
    v_smfmac_f32_32x32x32_bf16 v[192:207], v[44:47], v[120:127], v30
    v_exp_f32 v140, v140
    v_exp_f32 v141, v141
    v_exp_f32 v142, v142
    v_exp_f32 v143, v143
    v_mfma_f32_32x32x16_bf16 v[96:111], v[80:83], v[240:243], 0
    v_exp_f32 v144, v144
    v_exp_f32 v145, v145
    v_exp_f32 v146, v146
    v_exp_f32 v147, v147
    v_mfma_f32_32x32x16_bf16 v[96:111], v[84:87], v[244:247], v[96:111]
    v_exp_f32 v148, v148
    v_exp_f32 v149, v149
    v_exp_f32 v150, v150
    v_exp_f32 v151, v151
    v_smfmac_f32_32x32x32_bf16 v[160:175], v[48:51], v[128:135], v30
    v_exp_f32 v152, v152
    v_exp_f32 v153, v153
    v_exp_f32 v154, v154
    v_exp_f32 v155, v155
    v_smfmac_f32_32x32x32_bf16 v[160:175], v[52:55], v[136:143], v30
    s_waitcnt vmcnt(0)
    v_exp_f32 v156, v156
    v_exp_f32 v157, v157
    v_exp_f32 v158, v158
    v_exp_f32 v159, v159
    v_mfma_f32_32x32x16_bf16 v[112:127], v[88:91], v[224:227], 0
    v_exp_f32 v96, v96
    v_exp_f32 v97, v97
    v_exp_f32 v98, v98
    v_exp_f32 v99, v99
    v_mfma_f32_32x32x16_bf16 v[112:127], v[92:95], v[228:231], v[112:127]
    v_exp_f32 v100, v100
    v_exp_f32 v101, v101
    v_exp_f32 v102, v102
    v_exp_f32 v103, v103
    v_smfmac_f32_32x32x32_bf16 v[176:191], v[48:51], v[144:151], v30
    v_exp_f32 v104, v104
    v_exp_f32 v105, v105
    v_exp_f32 v106, v106
    v_exp_f32_e64 v107, v107
    v_smfmac_f32_32x32x32_bf16 v[176:191], v[52:55], v[152:159], v30
    v_exp_f32 v108, v108
    v_exp_f32 v109, v109
    v_exp_f32 v110, v110
    v_exp_f32 v111, v111
    v_mfma_f32_32x32x16_bf16 v[128:143], v[88:91], v[232:235], 0
    v_exp_f32 v112, v112
    v_exp_f32 v113, v113
    v_exp_f32 v114, v114
    v_exp_f32 v115, v115
    v_mfma_f32_32x32x16_bf16 v[128:143], v[92:95], v[236:239], v[128:143]
    v_exp_f32 v116, v116
    v_exp_f32 v117, v117
L_pad12:
    s_cbranch_execz L_pad_ret
    v_exp_f32 v118, v118
    v_exp_f32 v119, v119
    v_smfmac_f32_32x32x32_bf16 v[192:207], v[48:51], v[96:103], v30
    buffer_load_dword v31, v23, s[40:43], 0 offen sc1
    s_setprio 2
    v_exp_f32 v120, v120
    v_exp_f32 v121, v121
    v_exp_f32 v122, v122
    v_exp_f32 v123, v123
    v_smfmac_f32_32x32x32_bf16 v[192:207], v[52:55], v[104:111], v30
    v_exp_f32 v124, v124
    v_exp_f32 v125, v125
    v_exp_f32 v126, v126
    v_exp_f32 v127, v127
    v_mfma_f32_32x32x16_bf16 v[144:159], v[88:91], v[240:243], 0
    v_exp_f32 v128, v128
    v_exp_f32 v129, v129
    v_exp_f32 v130, v130
    v_exp_f32 v131, v131
    v_mfma_f32_32x32x16_bf16 v[144:159], v[92:95], v[244:247], v[144:159]
    v_exp_f32 v132, v132
    v_exp_f32 v133, v133
    v_exp_f32 v134, v134
    v_exp_f32 v135, v135
    v_smfmac_f32_32x32x32_bf16 v[160:175], v[56:59], v[112:119], v30
    v_exp_f32 v136, v136
    v_exp_f32 v137, v137
    v_exp_f32 v138, v138
    v_exp_f32 v139, v139
    v_smfmac_f32_32x32x32_bf16 v[160:175], v[60:63], v[120:127], v30
    v_exp_f32 v140, v140
    v_exp_f32 v141, v141
    v_exp_f32 v142, v142
    v_exp_f32 v143, v143
    v_mfma_f32_32x32x16_bf16 v[96:111], v[64:67], v[248:251], 0
    v_exp_f32 v144, v144
    v_exp_f32 v145, v145
    v_exp_f32 v146, v146
    v_exp_f32 v147, v147
    v_mfma_f32_32x32x16_bf16 v[96:111], v[68:71], v[252:255], v[96:111]
    v_exp_f32 v148, v148
    v_exp_f32 v149, v149
    v_exp_f32 v150, v150
    v_exp_f32 v151, v151
    v_smfmac_f32_32x32x32_bf16 v[176:191], v[56:59], v[128:135], v30
    ds_write_b128 v7, v[160:163] offset:0
    ds_write_b128 v7, v[164:167] offset:1024
    v_exp_f32 v152, v152
    v_exp_f32 v153, v153
    v_exp_f32 v154, v154
    v_exp_f32 v155, v155
    v_smfmac_f32_32x32x32_bf16 v[176:191], v[60:63], v[136:143], v30
    ds_write_b128 v7, v[168:171] offset:2048
    ds_write_b128 v7, v[172:175] offset:3072
    v_exp_f32 v156, v156
    v_exp_f32 v157, v157
    v_exp_f32 v158, v158
    v_exp_f32 v159, v159
    v_mfma_f32_32x32x16_bf16 v[112:127], v[72:75], v[248:251], 0
    v_exp_f32 v96, v96
    v_exp_f32 v97, v97
    v_exp_f32 v98, v98
    v_exp_f32 v99, v99
    v_mfma_f32_32x32x16_bf16 v[112:127], v[76:79], v[252:255], v[112:127]
    v_exp_f32 v100, v100
    v_exp_f32 v101, v101
    v_exp_f32 v102, v102
    v_exp_f32 v103, v103
    v_smfmac_f32_32x32x32_bf16 v[192:207], v[56:59], v[144:151], v30
    ds_write_b128 v8, v[176:179] offset:0
    ds_write_b128 v8, v[180:183] offset:1024
    v_exp_f32 v104, v104
    v_exp_f32 v105, v105
    v_exp_f32 v106, v106
    v_exp_f32 v107, v107
    v_smfmac_f32_32x32x32_bf16 v[192:207], v[60:63], v[152:159], v30
    ds_write_b128 v8, v[184:187] offset:2048
    ds_write_b128 v8, v[188:191] offset:3072
    v_exp_f32 v108, v108
    v_exp_f32 v109, v109
    v_exp_f32 v110, v110
    v_exp_f32 v111, v111
    v_mfma_f32_32x32x16_bf16 v[128:143], v[80:83], v[248:251], 0
    v_exp_f32 v112, v112
    v_exp_f32 v113, v113
    v_exp_f32 v114, v114
    v_exp_f32 v115, v115
    v_mfma_f32_32x32x16_bf16 v[128:143], v[84:87], v[252:255], v[128:143]
    v_exp_f32 v116, v116
    v_exp_f32 v117, v117
    v_exp_f32 v118, v118
    v_exp_f32 v119, v119
    v_smfmac_f32_32x32x32_bf16 v[208:223], v[32:35], v[96:103], v30
    ds_write_b128 v9, v[192:195] offset:0
    ds_write_b128 v9, v[196:199] offset:1024
    v_exp_f32 v120, v120
    v_exp_f32 v121, v121
    v_exp_f32 v122, v122
    v_exp_f32 v123, v123
    v_smfmac_f32_32x32x32_bf16 v[208:223], v[36:39], v[104:111], v30
    ds_write_b128 v9, v[200:203] offset:2048
    ds_write_b128 v9, v[204:207] offset:3072
    v_mov_b32_e64 v1, 9
    ds_write_b32 v2, v1
    v_exp_f32 v124, v124
    v_exp_f32 v125, v125
    v_exp_f32 v126, v126
    v_exp_f32 v127, v127
    v_mfma_f32_32x32x16_bf16 v[144:159], v[88:91], v[248:251], 0
    v_exp_f32 v128, v128
    v_exp_f32 v129, v129
    v_exp_f32 v130, v130
    v_exp_f32 v131, v131
    v_mfma_f32_32x32x16_bf16 v[144:159], v[92:95], v[252:255], v[144:159]
    v_exp_f32 v132, v132
    v_exp_f32 v133, v133
    v_exp_f32 v134, v134
    v_exp_f32 v135, v135
    v_smfmac_f32_32x32x32_bf16 v[208:223], v[40:43], v[112:119], v30
    v_exp_f32 v136, v136
    v_exp_f32 v137, v137
    v_exp_f32 v138, v138
    v_exp_f32 v139, v139
    v_smfmac_f32_32x32x32_bf16 v[208:223], v[44:47], v[120:127], v30
    ds_read_b32 v1, v3
    v_exp_f32 v140, v140
    v_exp_f32 v141, v141
    v_exp_f32 v142, v142
    v_exp_f32 v143, v143
    v_smfmac_f32_32x32x32_bf16 v[208:223], v[48:51], v[128:135], v30
    v_exp_f32 v144, v144
    v_exp_f32 v145, v145
    v_exp_f32 v146, v146
    v_exp_f32 v147, v147
    v_smfmac_f32_32x32x32_bf16 v[208:223], v[52:55], v[136:143], v30
L_rb_spin:
    s_waitcnt lgkmcnt(0)
    v_cmp_gt_u32 vcc, 9, v1
    ds_read_b32 v1, v3
    s_cbranch_vccnz L_rb_spin
    s_nop 0
    ds_read_b128 v[160:163], v10 offset:0
    ds_read_b128 v[164:167], v10 offset:1024
    ds_read_b128 v[168:171], v10 offset:2048
    ds_read_b128 v[172:175], v10 offset:3072
    ds_read_b128 v[176:179], v10 offset:4096
    ds_read_b128 v[180:183], v10 offset:5120
    ds_read_b128 v[184:187], v10 offset:6144
    ds_read_b128 v[188:191], v10 offset:7168
    ds_read_b128 v[192:195], v10 offset:8192
    ds_read_b128 v[196:199], v10 offset:9216
    ds_read_b128 v[200:203], v10 offset:10240
    ds_read_b128 v[204:207], v10 offset:11264
    v_exp_f32 v148, v148
    v_exp_f32 v149, v149
    v_exp_f32 v150, v150
    v_exp_f32 v151, v151
    v_exp_f32 v152, v152
    v_exp_f32 v153, v153
    v_smfmac_f32_32x32x32_bf16 v[208:223], v[56:59], v[144:151], v30
    v_exp_f32 v154, v154
    v_exp_f32 v155, v155
    v_exp_f32 v156, v156
    v_exp_f32 v157, v157
    v_exp_f32 v158, v158
    v_exp_f32_e64 v159, v159
    s_waitcnt lgkmcnt(0)
    v_pk_add_f32 v[160:161], v[160:161], v[176:177]
    v_pk_add_f32 v[162:163], v[162:163], v[178:179]
    v_smfmac_f32_32x32x32_bf16 v[208:223], v[60:63], v[152:159], v30
    v_pk_add_f32 v[164:165], v[164:165], v[180:181]
    v_pk_add_f32 v[166:167], v[166:167], v[182:183]
    v_pk_add_f32 v[168:169], v[168:169], v[184:185]
    v_pk_add_f32 v[170:171], v[170:171], v[186:187]
    v_pk_add_f32 v[172:173], v[172:173], v[188:189]
    v_pk_add_f32 v[174:175], v[174:175], v[190:191]
    v_pk_add_f32 v[160:161], v[160:161], v[192:193]
    v_pk_add_f32 v[162:163], v[162:163], v[194:195]
    v_pk_add_f32 v[164:165], v[164:165], v[196:197]
    v_pk_add_f32 v[166:167], v[166:167], v[198:199]
    v_pk_add_f32 v[168:169], v[168:169], v[200:201]
    v_pk_add_f32 v[170:171], v[170:171], v[202:203]
    v_pk_add_f32 v[172:173], v[172:173], v[204:205]
    v_pk_add_f32 v[174:175], v[174:175], v[206:207]
    v_pk_add_f32 v[208:209], v[208:209], v[160:161]
    v_pk_add_f32 v[210:211], v[210:211], v[162:163]
    v_pk_add_f32 v[212:213], v[212:213], v[164:165]
    v_pk_add_f32 v[214:215], v[214:215], v[166:167]
    v_pk_add_f32 v[216:217], v[216:217], v[168:169]
    v_pk_add_f32 v[218:219], v[218:219], v[170:171]
    v_pk_add_f32 v[220:221], v[220:221], v[172:173]
    v_pk_add_f32 v[222:223], v[222:223], v[174:175]
L_norm:
    v_cndmask_b32 v24, v220, v208, s[76:77]
    v_max3_f32 v26, abs(v208), abs(v209), abs(v210)
    v_mov_b32_e64 v25, v24
    v_max3_f32 v26, abs(v211), abs(v212), v26
    v_max3_f32 v26, abs(v213), abs(v214), v26
    v_permlane32_swap_b32 v24, v25
    v_max3_f32 v26, abs(v215), abs(v216), v26
    v_cndmask_b32 v25, v25, v24, s[76:77]
    v_max3_f32 v26, abs(v217), abs(v218), v26
    v_rcp_f32 v24, v25
    v_max3_f32 v26, abs(v219), abs(v220), v26
    v_max3_f32 v26, abs(v221), abs(v222), v26
    v_max_f32 v26, abs(v223), v26
    v_subrev_u32 v25, 0x30800000, v25
    v_cmp_lt_u32 s[78:79], s9, v25
    v_cmp_ngt_f32 vcc, 0x7f000000, v26
    s_waitcnt vmcnt(0)
    v_cmp_ne_u32 s[80:81], s37, v31
    v_pk_mul_f32 v[208:209], v[208:209], v[24:25] op_sel_hi:[1,0]
    v_pk_mul_f32 v[210:211], v[210:211], v[24:25] op_sel_hi:[1,0]
L_pad13:
    s_cbranch_execz L_pad_ret
    v_pk_mul_f32 v[212:213], v[212:213], v[24:25] op_sel_hi:[1,0]
    v_pk_mul_f32 v[214:215], v[214:215], v[24:25] op_sel_hi:[1,0]
    s_or_b64 s[78:79], s[78:79], vcc
    v_pk_mul_f32 v[216:217], v[216:217], v[24:25] op_sel_hi:[1,0]
    v_pk_mul_f32 v[218:219], v[218:219], v[24:25] op_sel_hi:[1,0]
    v_pk_mul_f32 v[220:221], v[220:221], v[24:25] op_sel_hi:[1,0]
    v_pk_mul_f32 v[222:223], v[222:223], v[24:25] op_sel_hi:[1,0]
    s_or_b64 vcc, s[78:79], s[80:81]
    s_cbranch_vccnz L_fb0
L_norm2:
    v_cvt_pk_bf16_f32 v96, v208, v209
    v_cvt_pk_bf16_f32 v97, v210, v211
    v_cvt_pk_bf16_f32 v98, v212, v213
    v_cvt_pk_bf16_f32 v99, v214, v215
    v_cvt_pk_bf16_f32 v100, v216, v217
    v_cvt_pk_bf16_f32 v101, v218, v219
    v_cvt_pk_bf16_f32 v102, v220, v221
    v_cvt_pk_bf16_f32 v103, v222, v223
    v_cndmask_b32 v104, v100, v98, s[76:77]
    v_cndmask_b32 v105, v101, v99, s[76:77]
    s_mov_b64 exec, s[4:5]
    buffer_store_dwordx4 v[96:99], v18, s[40:43], s85 offen sc1
    s_mov_b64 exec, s[6:7]
    buffer_store_dwordx4 v[100:103], v18, s[40:43], s86 offen sc1
    s_not_b64 exec, s[10:11]
    buffer_store_dwordx2 v[104:105], v18, s[40:43], s8 offen sc1
    s_mov_b64 exec, -1
    s_waitcnt vmcnt(1)
    s_barrier
    s_endpgm
L_ssm_idle:
    s_setprio 3
    v_lshrrev_b32 v10, 3, v0
    v_and_b32 v11, 7, v0
    v_lshlrev_b32 v11, 4, v11
    v_mul_u32_u24 v5, 896, v10
    v_add_u32 v5, v5, v11
    v_add_u32 v6, 6144, v5
    s_lshl2_add_u32 s60, s35, s31
    s_mul_i32 s61, s60, 14336
    s_mul_i32 s62, s31, 14336
    s_add_u32 s62, s62, 1024
    s_mov_b32 s46, 1835008
    s_mov_b32 s47, 0x20000
    s_waitcnt lgkmcnt(0)
    s_mov_b64 s[44:45], s[4:5]
    s_add_u32 m0, s62, 0
    s_nop 0
    buffer_load_dwordx4 v5, s[44:47], s61 offen offset:0 lds
    buffer_load_dwordx4 v6, s[44:47], s61 offen offset:1024 lds
    s_add_u32 m0, s62, 1920
    s_nop 0
    buffer_load_dwordx4 v5, s[44:47], s61 offen offset:128 lds
    buffer_load_dwordx4 v6, s[44:47], s61 offen offset:1152 lds
    s_mov_b64 s[40:41], s[28:29]
    s_mov_b32 s42, 16777216
    s_mov_b32 s43, 0x20000
    v_mul_u32_u24 v7, 16384, v10
    v_add_u32 v7, v7, v11
    v_bfe_u32 v8, v0, 2, 2
    v_and_b32 v9, 1, v0
    v_lshl_or_b32 v8, v9, 3, v8
    v_xor_b32_e64 v8, 3, v8
    v_lshl_add_u32 v8, v8, 7, s62
    v_and_b32 v9, 0x30, v0
    v_add_u32 v8, v8, v9
    v_and_b32 v9, 2, v0
    v_lshl_add_u32 v8, v9, 2, v8
    s_lshl_b32 s63, s60, 7
    s_add_u32 s63, s63, 7340032
    s_mul_i32 s65, s35, 128
    v_mov_b32_e64 v12, 0
    s_mov_b64 exec, 0x1111
    v_mov_b32 v12, 0x3f803f80
    s_mov_b64 exec, -1
    v_mov_b32 v13, v12
    v_mov_b64 v[14:15], v[12:13]
    v_lshlrev_b32 v9, 4, v0
    s_lshl2_add_u32 s66, s34, s31
    s_lshl_b32 s66, s66, 8
    s_mul_i32 s67, s32, 16384
    s_add_u32 s66, s66, s67
    s_add_u32 s66, s66, 4980736
    s_add_u32 s65, s65, 266240
    s_add_u32 m0, s62, 3840
    s_nop 0
    buffer_load_dwordx4 v5, s[44:47], s61 offen offset:256 lds
    buffer_load_dwordx4 v6, s[44:47], s61 offen offset:1280 lds
    s_add_u32 m0, s62, 5760
    s_nop 0
    buffer_load_dwordx4 v5, s[44:47], s61 offen offset:384 lds
    buffer_load_dwordx4 v6, s[44:47], s61 offen offset:1408 lds
    s_add_u32 m0, s62, 7680
    s_nop 0
    buffer_load_dwordx4 v5, s[44:47], s61 offen offset:512 lds
    buffer_load_dwordx4 v6, s[44:47], s61 offen offset:1536 lds
    s_add_u32 m0, s62, 9600
    s_nop 0
    buffer_load_dwordx4 v5, s[44:47], s61 offen offset:640 lds
    buffer_load_dwordx4 v6, s[44:47], s61 offen offset:1664 lds
    s_add_u32 m0, s62, 11520
    s_nop 0
    buffer_load_dwordx4 v5, s[44:47], s61 offen offset:768 lds
    buffer_load_dwordx4 v6, s[44:47], s61 offen offset:1792 lds
    s_waitcnt vmcnt(12)
    ds_read_b64_tr_b16 v[16:17], v8 offset:512
    ds_read_b64_tr_b16 v[18:19], v8 offset:0
    ds_read_b64_tr_b16 v[20:21], v8 offset:576
    ds_read_b64_tr_b16 v[22:23], v8 offset:64
    s_waitcnt vmcnt(10)
    ds_read_b64_tr_b16 v[24:25], v8 offset:2560
    ds_read_b64_tr_b16 v[26:27], v8 offset:2048
    ds_read_b64_tr_b16 v[28:29], v8 offset:2624
    ds_read_b64_tr_b16 v[30:31], v8 offset:2112
    s_add_u32 s64, s63, 131072
    s_waitcnt lgkmcnt(4)
    buffer_store_dwordx4 v[16:19], v7, s[40:43], s63 offen sc1
    buffer_store_dwordx4 v[20:23], v7, s[40:43], s64 offen sc1
    s_add_u32 s63, s63, 262144
    s_waitcnt vmcnt(10)
    ds_read_b64_tr_b16 v[32:33], v8 offset:4608
    ds_read_b64_tr_b16 v[34:35], v8 offset:4096
    ds_read_b64_tr_b16 v[36:37], v8 offset:4672
    ds_read_b64_tr_b16 v[38:39], v8 offset:4160
    s_add_u32 s64, s63, 131072
    s_waitcnt lgkmcnt(4)
    buffer_store_dwordx4 v[24:27], v7, s[40:43], s63 offen sc1
    buffer_store_dwordx4 v[28:31], v7, s[40:43], s64 offen sc1
    s_add_u32 s63, s63, 262144
    s_waitcnt vmcnt(10)
    ds_read_b64_tr_b16 v[40:41], v8 offset:6656
    ds_read_b64_tr_b16 v[42:43], v8 offset:6144
    ds_read_b64_tr_b16 v[44:45], v8 offset:6720
    ds_read_b64_tr_b16 v[46:47], v8 offset:6208
    s_add_u32 s64, s63, 131072
    s_waitcnt lgkmcnt(4)
    buffer_store_dwordx4 v[32:35], v7, s[40:43], s63 offen sc1
    buffer_store_dwordx4 v[36:39], v7, s[40:43], s64 offen sc1
    s_add_u32 s63, s63, 262144
    s_waitcnt vmcnt(10)
    ds_read_b64_tr_b16 v[48:49], v8 offset:8704
    ds_read_b64_tr_b16 v[50:51], v8 offset:8192
    ds_read_b64_tr_b16 v[52:53], v8 offset:8768
    ds_read_b64_tr_b16 v[54:55], v8 offset:8256
    s_add_u32 s64, s63, 131072
    s_waitcnt lgkmcnt(4)
    buffer_store_dwordx4 v[40:43], v7, s[40:43], s63 offen sc1
    buffer_store_dwordx4 v[44:47], v7, s[40:43], s64 offen sc1
    s_add_u32 s63, s63, 262144
    s_waitcnt vmcnt(10)
    ds_read_b64_tr_b16 v[56:57], v8 offset:10752
    ds_read_b64_tr_b16 v[58:59], v8 offset:10240
    ds_read_b64_tr_b16 v[60:61], v8 offset:10816
    ds_read_b64_tr_b16 v[62:63], v8 offset:10304
    s_add_u32 s64, s63, 131072
    s_waitcnt lgkmcnt(4)
    buffer_store_dwordx4 v[48:51], v7, s[40:43], s63 offen sc1
    buffer_store_dwordx4 v[52:55], v7, s[40:43], s64 offen sc1
    s_add_u32 s63, s63, 262144
    s_waitcnt vmcnt(10)
    ds_read_b64_tr_b16 v[64:65], v8 offset:12800
    ds_read_b64_tr_b16 v[66:67], v8 offset:12288
    ds_read_b64_tr_b16 v[68:69], v8 offset:12864
    ds_read_b64_tr_b16 v[70:71], v8 offset:12352
    s_add_u32 s64, s63, 131072
    s_waitcnt lgkmcnt(4)
    buffer_store_dwordx4 v[56:59], v7, s[40:43], s63 offen sc1
    buffer_store_dwordx4 v[60:63], v7, s[40:43], s64 offen sc1
    s_add_u32 s63, s63, 262144
    s_add_u32 s64, s63, 131072
    s_waitcnt lgkmcnt(0)
    s_load_dword s37, s[28:29], 0
    buffer_store_dwordx4 v[64:67], v7, s[40:43], s63 offen sc1
    buffer_store_dwordx4 v[68:71], v7, s[40:43], s64 offen sc1
    s_add_u32 s63, s63, 262144
    s_mov_b64 exec, 0xffff
    buffer_store_dwordx4 v[12:15], v9, s[40:43], s66 offen sc1
    s_mov_b64 exec, 0xff
    s_waitcnt lgkmcnt(0)
    s_add_u32 s37, s37, 0x9e3779b9
    v_mul_u32_u24 v6, 4096, v0
    v_mov_b32 v5, s37
    s_cmp_lg_u32 s31, 0
    s_waitcnt vmcnt(0)
    s_barrier
    s_cbranch_scc1 L_idle_end
    buffer_store_dword v5, v6, s[40:43], s65 offen sc1
L_idle_end:
    s_mov_b64 exec, -1
    s_endpgm
    s_nop 0
L_gemm_t:
    s_mov_b64 s[40:41], s[28:29]
    s_mov_b32 s42, 16777216
    s_mov_b32 s43, 0x20000
    v_and_b32 v24, 31, v0
    v_lshrrev_b32 v19, 5, v0
    v_lshrrev_b32 v25, 1, v24
    v_xor_b32 v25, v25, v24
    v_and_b32 v25, 4, v25
    v_mul_u32_u24 v25, 3, v25
    v_xor_b32 v18, v25, v24
    v_bfe_u32 v25, v18, 1, 3
    v_xor_b32 v25, v25, v19
    v_lshlrev_b32_e64 v25, 4, v25
    v_lshl_add_u32 v25, v18, 7, v25
    v_add_u32 v11, s64, v25
    v_xor_b32 v12, 32, v11
    v_xor_b32 v13, 64, v11
    v_xor_b32 v14, 0x60, v11
    v_and_b32 v25, 3, v0
    v_lshrrev_b32 v26, 1, v25
    v_and_b32 v21, 1, v25
    v_lshl_or_b32 v26, v21, 1, v26
    v_bfe_u32 v21, v0, 4, 1
    v_lshl_or_b32 v25, v21, 2, v25
    v_lshl_or_b32 v26, v21, 2, v26
    v_bfe_u32 v21, v0, 2, 2
    v_lshl_or_b32 v23, v19, 3, v21
    v_lshlrev_b32_e64 v22, 6, v23
    v_lshl_add_u32 v22, v26, 3, v22
    v_add_u32 v22, 118784, v22
    s_cmp_eq_u32 s32, 0
    s_cselect_b64 vcc, -1, 0
    v_cndmask_b32 v25, v25, v26, vcc
    v_lshlrev_b32 v15, 7, v23
    v_lshl_add_u32 v15, v25, 3, v15
    v_lshrrev_b32 v21, 1, v21
    v_lshl_add_u32 v15, v21, 6, v15
    v_add_u32 v16, 57344, v15
    v_lshlrev_b32 v25, 4, v18
    v_mad_u32_u24 v25, v19, s57, v25
    v_lshrrev_b32 v26, 2, v24
    v_mul_u32_u24 v26, 16384, v26
    v_lshl_add_u32 v26, v19, 6, v26
    v_and_b32 v21, 3, v24
    v_lshl_add_u32 v26, v21, 4, v26
    v_cndmask_b32 v20, v26, v25, vcc
    s_lshl2_add_u32 s65, s34, s31
    s_lshl_b32 s66, s65, 9
    s_add_u32 s66, s66, 1048576
    s_lshl_b32 s65, s65, 8
    s_add_u32 s65, s65, 3145728
    s_movk_i32 s69, 128
    s_cmp_eq_u32 s32, 0
    s_cselect_b32 s67, s66, s65
    s_cselect_b32 s69, 65536, s69
    s_mul_i32 s65, s33, 262144
    s_add_u32 s67, s67, s65
    v_lshrrev_b32 v25, 2, v0
    v_mul_u32_u24 v25, 2688, v25
    v_lshl_add_u32 v21, v21, 4, v25
    s_lshl_b32 s82, s38, 4
    s_mul_i32 s65, s31, 43008
    s_add_u32 s82, s82, s65
    s_lshr_b32 s65, s38, 3
    s_add_u32 s66, s38, 3
    s_lshr_b32 s66, s66, 3
    s_sub_u32 s66, s66, s65
    v_bfe_u32 v26, v0, 4, 1
    v_mul_u32_u24 v26, s66, v26
    v_lshl_add_u32 v26, v19, 3, v26
    v_add_u32 v26, s65, v26
    v_and_b32 v25, 15, v0
    v_cmp_lt_u32 vcc, 7, v25
    v_and_b32 v25, 3, v0
    v_lshl_add_u32 v26, v26, 6, v25
    s_lshl_b32 s65, s31, 2
    v_add_u32 v26, s65, v26
    v_lshlrev_b32 v26, 7, v26
    v_add_u32 v23, 4096, v26
    s_and_b32 s65, s2, 7
    s_lshl2_add_u32 s65, s65, s31
    s_lshl3_add_u32 s65, s65, s32
    s_mul_i32 s65, s65, 128
    s_add_u32 s65, s65, 266240
    v_mul_u32_u24 v25, 256, v25
    v_add_u32 v25, s65, v25
    v_cndmask_b32 v23, v23, v25, vcc
    v_lshlrev_b32 v27, 4, v24
    v_mad_u32_u24 v27, v19, s57, v27
    v_add_u32 v28, 65536, v27
    v_lshrrev_b32 v24, 2, v18
    s_bitcmp1_b32 s36, 0
    s_cselect_b32 s65, 0, 7
    v_cmp_eq_u32 vcc, s65, v24
    s_lshl_b32 s65, s38, 1
    s_sub_u32 s65, s32, s65
    s_add_u32 s65, s65, 112
    v_mov_b32 v25, s65
    v_cndmask_b32 v24, v24, v25, vcc
    v_mul_u32_u24 v24, 16384, v24
    v_lshl_add_u32 v24, v19, 6, v24
    v_and_b32 v25, 3, v0
    v_lshl_add_u32 v29, v25, 4, v24
    v_mov_b32 v30, 0xdddddddd
    s_mul_i32 s65, s38, 32768
    s_lshl_b32 s71, s31, 13
    s_add_u32 s71, s71, s65
    s_add_u32 s71, s71, 1048576
    s_lshl_b32 s72, s31, 12
    s_add_u32 s72, s72, s65
    s_add_u32 s72, s72, 3145728
    s_lshl2_add_u32 s66, s34, s31
    s_lshl_b32 s66, s66, 9
    s_add_u32 s85, s65, s66
    s_add_u32 s85, s85, 5242880
    s_add_u32 s86, s85, 65536
    s_bitcmp1_b32 s36, 0
    s_cselect_b64 s[76:77], -1, 0
    v_mov_b32 v26, 0x3e8b97f6
    v_cmp_gt_u32 vcc, 32, v0
    s_and_b64 s[78:79], vcc, s[76:77]
    s_nor_b64 s[80:81], vcc, s[76:77]
    v_cndmask_b32 v24, v26, 0, s[78:79]
    v_cndmask_b32 v25, v26, 0, s[80:81]
    s_mov_b32 s78, 0x3f803f80
    s_mov_b32 s79, s78
    v_xor_b32 v17, 64, v16
    v_subrev_u32 v15, 61440, v22
    s_lshl_b32 s74, s31, 10
    s_add_u32 s74, s74, 57344
    v_lshlrev_b32 v18, 4, v18
    v_mad_u32_u24 v18, v19, s57, v18
    v_lshl_add_u32 v19, v0, 4, s64
    s_waitcnt lgkmcnt(0)
    s_add_u32 s37, s37, 0x9e3779b9
    s_barrier
    s_add_u32 m0, s64, 0
    s_nop 0
    buffer_load_dwordx4 v7, s[44:47], s60 offen offset:0 lds
    buffer_load_dwordx4 v8, s[44:47], s60 offen offset:1024 lds
    buffer_load_dwordx4 v9, s[44:47], s60 offen offset:2048 lds
    buffer_load_dwordx4 v10, s[44:47], s60 offen offset:3072 lds
    s_add_u32 m0, s64, 8064
    s_nop 0
    buffer_load_dwordx4 v7, s[44:47], s60 offen offset:128 lds
    buffer_load_dwordx4 v8, s[44:47], s60 offen offset:1152 lds
    buffer_load_dwordx4 v9, s[44:47], s60 offen offset:2176 lds
    buffer_load_dwordx4 v10, s[44:47], s60 offen offset:3200 lds
    s_add_u32 m0, s64, -113920
    s_nop 0
    buffer_load_dwordx4 v7, s[44:47], s60 offen offset:256 lds
    buffer_load_dwordx4 v8, s[44:47], s60 offen offset:1280 lds
    buffer_load_dwordx4 v9, s[44:47], s60 offen offset:2304 lds
    buffer_load_dwordx4 v10, s[44:47], s60 offen offset:3328 lds
    s_add_u32 m0, s64, -109952
    s_nop 0
    buffer_load_dwordx4 v7, s[44:47], s60 offen offset:384 lds
    buffer_load_dwordx4 v8, s[44:47], s60 offen offset:1408 lds
    buffer_load_dwordx4 v9, s[44:47], s60 offen offset:2432 lds
    buffer_load_dwordx4 v10, s[44:47], s60 offen offset:3456 lds
    s_add_u32 m0, s64, -105984
    s_nop 0
    buffer_load_dwordx4 v7, s[44:47], s60 offen offset:512 lds
    buffer_load_dwordx4 v8, s[44:47], s60 offen offset:1536 lds
    buffer_load_dwordx4 v9, s[44:47], s60 offen offset:2560 lds
    buffer_load_dwordx4 v10, s[44:47], s60 offen offset:3584 lds
    s_add_u32 m0, s64, -41600
    s_nop 0
    buffer_load_dwordx4 v7, s[44:47], s60 offen offset:640 lds
    buffer_load_dwordx4 v8, s[44:47], s60 offen offset:1664 lds
    buffer_load_dwordx4 v9, s[44:47], s60 offen offset:2688 lds
    buffer_load_dwordx4 v10, s[44:47], s60 offen offset:3712 lds
    s_waitcnt vmcnt(20)
    ds_read_b128 v[144:147], v11 offset:0
    ds_read_b128 v[148:151], v12 offset:0
    ds_read_b128 v[152:155], v13 offset:0
    ds_read_b128 v[156:159], v14 offset:0
    s_waitcnt lgkmcnt(0)
    s_add_u32 m0, s64, -768
    s_nop 0
    buffer_load_dwordx4 v7, s[44:47], s60 offen offset:768 lds
    buffer_load_dwordx4 v8, s[44:47], s60 offen offset:1792 lds
    buffer_load_dwordx4 v9, s[44:47], s60 offen offset:2816 lds
    buffer_load_dwordx4 v10, s[44:47], s60 offen offset:3840 lds
    s_add_u32 m0, s74, 0
    s_add_u32 s83, s82, 0
    buffer_load_dwordx4 v21, s[48:51], s83 offen lds
    s_add_u32 m0, s74, 4096
    s_add_u32 s83, s82, 172032
    buffer_load_dwordx4 v21, s[48:51], s83 offen lds
    s_add_u32 m0, s74, 8192
    s_add_u32 s83, s82, 344064
    buffer_load_dwordx4 v21, s[48:51], s83 offen lds
    s_add_u32 m0, s74, 12288
    s_add_u32 s83, s82, 516096
    buffer_load_dwordx4 v21, s[48:51], s83 offen lds
    s_add_u32 m0, s64, 4096
    s_add_u32 s83, s82, 688128
    buffer_load_dwordx4 v21, s[48:51], s83 offen lds
    s_add_u32 m0, s64, 5120
    s_add_u32 s83, s82, 860160
    buffer_load_dwordx4 v21, s[48:51], s83 offen lds
    s_add_u32 m0, s64, 6144
    s_add_u32 s83, s82, 1032192
    buffer_load_dwordx4 v21, s[48:51], s83 offen lds
    s_waitcnt vmcnt(27)
    ds_read_b128 v[160:163], v11 offset:8192
    ds_read_b128 v[164:167], v12 offset:8192
    ds_read_b128 v[168:171], v13 offset:8192
    ds_read_b128 v[172:175], v14 offset:8192
    s_waitcnt vmcnt(23)
    v_add_u32 v11, -113664, v11
    v_add_u32 v12, -113664, v12
    v_add_u32 v13, -113664, v13
    v_add_u32 v14, -113664, v14
    ds_read_b128 v[176:179], v11 offset:0
    ds_read_b128 v[180:183], v12 offset:0
    ds_read_b128 v[184:187], v13 offset:0
    ds_read_b128 v[188:191], v14 offset:0
    s_waitcnt vmcnt(19)
    ds_read_b128 v[192:195], v11 offset:4096
    ds_read_b128 v[196:199], v12 offset:4096
    ds_read_b128 v[200:203], v13 offset:4096
    ds_read_b128 v[204:207], v14 offset:4096
    s_waitcnt vmcnt(15)
    ds_read_b128 v[208:211], v11 offset:8192
    ds_read_b128 v[212:215], v12 offset:8192
    ds_read_b128 v[216:219], v13 offset:8192
    ds_read_b128 v[220:223], v14 offset:8192
    s_waitcnt vmcnt(11)
    v_add_u32 v11, 72704, v11
    v_add_u32 v12, 72704, v12
    v_add_u32 v13, 72704, v13
    v_add_u32 v14, 72704, v14
    ds_read_b128 v[224:227], v11 offset:0
    ds_read_b128 v[228:231], v12 offset:0
    ds_read_b128 v[232:235], v13 offset:0
    ds_read_b128 v[236:239], v14 offset:0
    s_waitcnt vmcnt(7)
    v_add_u32 v11, 40960, v11
    v_add_u32 v12, 40960, v12
    v_add_u32 v13, 40960, v13
    v_add_u32 v14, 40960, v14
    ds_read_b128 v[240:243], v11 offset:0
    ds_read_b128 v[244:247], v12 offset:0
    ds_read_b128 v[248:251], v13 offset:0
    ds_read_b128 v[252:255], v14 offset:0
    s_waitcnt vmcnt(0) lgkmcnt(0)
    v_mov_b32 v1, 7
    ds_write_b32 v2, v1
    s_branch L_nokv
L_fb0:
L_pl_7:
    buffer_load_dword v31, v23, s[40:43], 0 offen sc1
L_pm_9:
    s_waitcnt vmcnt(0)
    v_cmp_ne_u32 vcc, s37, v31
    s_cbranch_vccz L_pd_8
    s_sub_u32 s56, s56, 1
    s_cbranch_scc0 L_pl_7
    s_mov_b32 s56, 0
L_pd_8:
    s_cmp_eq_u64 s[78:79], 0
    s_cbranch_scc1 L_norm2
    s_cmp_eq_u32 s73, 2
    s_cbranch_scc1 L_norm2
L_fb:
    s_waitcnt vmcnt(0)
    s_mul_i32 s65, s38, 32768
    s_add_u32 s71, s65, 1048576
    s_add_u32 s72, s65, 3145728
    v_mov_b32 v26, 0xff800000
    s_mov_b32 s73, 0
L_fb1:
    buffer_load_dwordx4 v[64:67], v27, s[40:43], s71 offen offset:0 sc1
    buffer_load_dwordx4 v[68:71], v28, s[40:43], s71 offen offset:0 sc1
    s_waitcnt vmcnt(0)
    v_mfma_f32_32x32x16_bf16 v[144:159], v[64:67], v[248:251], 0
    v_mfma_f32_32x32x16_bf16 v[144:159], v[68:71], v[252:255], v[144:159]
    s_nop 11
    v_max3_f32 v26, v144, v145, v26
    v_max3_f32 v26, v146, v147, v26
    v_max3_f32 v26, v148, v149, v26
    v_max3_f32 v26, v150, v151, v26
    v_max3_f32 v26, v152, v153, v26
    v_max3_f32 v26, v154, v155, v26
    v_max3_f32 v26, v156, v157, v26
    v_max3_f32 v26, v158, v159, v26
    s_add_u32 s71, s71, 512
    s_add_u32 s73, s73, 1
    s_cmp_lg_u32 s73, 64
    s_cbranch_scc1 L_fb1
    v_mov_b32_e64 v24, v26
    s_sub_u32 s71, s71, 0x8000
    s_mov_b32 s73, 0
    v_permlane32_swap_b32 v24, v26
    v_max_f32 v26, v24, v26
    v_mov_b64 v[208:209], 0
    v_mov_b64 v[210:211], 0
    v_mov_b64 v[212:213], 0
    v_mov_b64 v[214:215], 0
    v_mov_b64 v[216:217], 0
    v_mov_b64 v[218:219], 0
    v_mov_b64 v[220:221], 0
    v_mov_b64_e64 v[222:223], 0
L_fb2:
    buffer_load_dwordx4 v[64:67], v27, s[40:43], s71 offen offset:0 sc1
    buffer_load_dwordx4 v[68:71], v28, s[40:43], s71 offen offset:0 sc1
    buffer_load_dwordx4 v[32:35], v29, s[40:43], s72 offen offset:0 sc1
    buffer_load_dwordx4 v[36:39], v29, s[40:43], s72 offen offset:128 sc1
    s_waitcnt vmcnt(0)
    v_mfma_f32_32x32x16_bf16 v[144:159], v[64:67], v[248:251], 0
    v_mfma_f32_32x32x16_bf16 v[144:159], v[68:71], v[252:255], v[144:159]
    s_nop 11
    v_sub_f32 v144, v144, v26
    v_sub_f32 v145, v145, v26
    v_sub_f32 v146, v146, v26
    v_sub_f32 v147, v147, v26
    v_sub_f32 v148, v148, v26
    v_sub_f32 v149, v149, v26
    v_sub_f32 v150, v150, v26
    v_sub_f32 v151, v151, v26
    v_sub_f32 v152, v152, v26
    v_sub_f32 v153, v153, v26
    v_sub_f32 v154, v154, v26
    v_sub_f32 v155, v155, v26
    v_sub_f32 v156, v156, v26
    v_sub_f32 v157, v157, v26
    v_sub_f32 v158, v158, v26
    v_sub_f32 v159, v159, v26
    v_exp_f32 v144, v144
    v_exp_f32 v145, v145
    v_exp_f32 v146, v146
    v_exp_f32 v147, v147
    v_exp_f32 v148, v148
    v_exp_f32 v149, v149
    v_exp_f32 v150, v150
    v_exp_f32 v151, v151
    v_exp_f32 v152, v152
    v_exp_f32 v153, v153
    v_exp_f32 v154, v154
    v_exp_f32 v155, v155
    v_exp_f32 v156, v156
    v_exp_f32 v157, v157
    v_exp_f32 v158, v158
    v_exp_f32_e64 v159, v159
    s_nop 1
    v_smfmac_f32_32x32x32_bf16 v[208:223], v[32:35], v[144:151], v30
    v_smfmac_f32_32x32x32_bf16 v[208:223], v[36:39], v[152:159], v30
    s_add_u32 s71, s71, 512
    s_add_u32 s72, s72, 256
    s_add_u32 s73, s73, 1
    s_cmp_lg_u32 s73, 64
    s_cbranch_scc1 L_fb2
    s_mov_b32 s73, 2
    s_nop 11
    s_branch L_norm
.section .rodata,"a"
.p2align 6
.amdhsa_kernel concat_heads__ssm_conv_s4d__softmax_full_mha__prompt_kernel
  .amdhsa_next_free_vgpr 256
  .amdhsa_next_free_sgpr 102
  .amdhsa_accum_offset 256
  .amdhsa_group_segment_fixed_size 0
  .amdhsa_kernarg_size 104
  .amdhsa_user_sgpr_count 2
  .amdhsa_user_sgpr_kernarg_segment_ptr 1
  .amdhsa_system_sgpr_workgroup_id_x 1
.end_amdhsa_kernel
```
